```python
import torch

def _softmax(x, axis=-1):
    return torch.softmax(x, dim=axis)
def _gelu(x):
    return torch.nn.functional.gelu(x, approximate="tanh")
def _silu(x):
    return torch.nn.functional.silu(x)
def _sigmoid(x):
    return torch.sigmoid(x)
def _layernorm(x, axis=-1, eps=1e-5):
    m = x.mean(dim=axis, keepdim=True)
    v = x.var(dim=axis, keepdim=True, unbiased=False)
    return (x - m) / torch.sqrt(v + eps)
def _scatter_add(tgt, idx, src, axis=0):
    return tgt.clone().index_add_(axis, idx, src)
def _segment_sum(src, seg, n):
    out = torch.zeros((n,) + src.shape[1:], dtype=src.dtype)
    return out.index_add_(0, seg, src)
def _pad(x, pw):
    flat = tuple(v for pair in reversed(pw) for v in pair)
    return torch.nn.functional.pad(x, flat)

kernel_name = 'interleave_layers__linear_kernel_hedgehog__glu_gated_glu__prompt'

def setup_inputs():

    _w = (lambda a: (lambda t: t.to(torch.bfloat16) if t.is_floating_point() else t)(torch.as_tensor(a)))
    def _A_setup():
        B, S, D, H = 1, 2048, 448, 16
        Dh = D // H
        return {
            "x": _w((lambda *s: torch.randn(*s, dtype=torch.bfloat16) * 0.05)(B, S, D)),
            "wqkv": _w((lambda *s: torch.randn(*s, dtype=torch.bfloat16) * 0.4)(D, 3 * D)),
            "w_phi": _w((lambda *s: torch.randn(*s, dtype=torch.bfloat16) * 0.4)(H, Dh, Dh) * (Dh ** -0.5)),
            "wo": _w((lambda *s: torch.randn(*s, dtype=torch.bfloat16) * 0.05)(D, D)),
        }
    _A_in = _A_setup()

    def _B_setup():
        B, S, D, F = 1, 2048, 448, 1792
        return {
            "x": _w((lambda *s: torch.randn(*s, dtype=torch.bfloat16) * 0.05)(B, S, D)),
            "w_gate": _w((lambda *s: torch.randn(*s, dtype=torch.bfloat16) * 0.05)(D, F)),
            "w_up": _w((lambda *s: torch.randn(*s, dtype=torch.bfloat16) * 0.05)(D, F)),
            "w_down": _w((lambda *s: torch.randn(*s, dtype=torch.bfloat16) * 0.05)(F, D)),
        }
    _B_in = _B_setup()

    return {
        "A_x": _A_in["x"],
        "A_wqkv": _A_in["wqkv"],
        "A_w_phi": _A_in["w_phi"],
        "A_wo": _A_in["wo"],
        "B_x": _B_in["x"],
        "B_w_gate": _B_in["w_gate"],
        "B_w_up": _B_in["w_up"],
        "B_w_down": _B_in["w_down"],
    }

def reference(A_x, A_wqkv, A_w_phi, A_wo, B_x, B_w_gate, B_w_up, B_w_down):
    def _A_ref(x, wqkv, w_phi, wo):
        B, S, D = x.shape
        H = 16; Dh = D // H
        qkv = (lambda x, *d: x.permute(*d))((x @ wqkv).reshape(B, S, 3, H, Dh), 2, 0, 3, 1, 4)
        q, k, v = qkv[0], qkv[1], qkv[2]
        pq = torch.einsum("bhsd,hdf->bhsf", q, w_phi)
        pk = torch.einsum("bhsd,hdf->bhsf", k, w_phi)
        phi_q = torch.concatenate([_softmax(pq, axis=-1), _softmax(-pq, axis=-1)], axis=-1)
        phi_k = torch.concatenate([_softmax(pk, axis=-1), _softmax(-pk, axis=-1)], axis=-1)
        kv = torch.einsum("bhsf,bhsd->bhfd", phi_k, v)
        z  = torch.einsum("bhsf->bhf", phi_k)
        num = torch.einsum("bhqf,bhfd->bhqd", phi_q, kv)
        den = torch.einsum("bhqf,bhf->bhq", phi_q, z)[..., None] + 1e-6
        o = num / den
        return (lambda x, *d: x.permute(*d))(o, 0, 2, 1, 3).reshape(B, S, D) @ wo

    def _B_ref(x, w_gate, w_up, w_down):
        g = torch.einsum("bsd,df->bsf", x, w_gate)
        u = torch.einsum("bsd,df->bsf", x, w_up)
        h = _sigmoid(g) * u
        return torch.einsum("bsf,fd->bsd", h, w_down)

    x = A_x
    x = x + _A_ref(_layernorm(x, axis=-1), A_wqkv, A_w_phi, A_wo)
    x = x + _B_ref(_layernorm(x, axis=-1), B_w_gate, B_w_up, B_w_down)
    x = x + _A_ref(_layernorm(x, axis=-1), A_wqkv, A_w_phi, A_wo)
    x = x + _B_ref(_layernorm(x, axis=-1), B_w_gate, B_w_up, B_w_down)
    return x
```

```asm
; @launch kernel=prep_kernel grid=(267,1,1) block=(256,1,1) lds=57344
; @launch kernel=megal0_kernel grid=(256,1,1) block=(512,1,1) lds=151552
.amdgcn_target "amdgcn-amd-amdhsa--gfx950"
.text
.globl prep_kernel
.p2align 8
.type prep_kernel,@function
prep_kernel:
    s_cmp_ge_u32 s2, 267
    s_cbranch_scc1 prep_done
    s_load_dwordx16 s[4:19], s[0:1], 0
    s_load_dwordx2 s[20:21], s[0:1], 80
    v_and_b32 v1, 63, v0
    v_lshrrev_b32 v2, 6, v0
    s_nop 0
    v_readfirstlane_b32 s3, v2
    v_and_b32 v3, 15, v1
    v_lshrrev_b32 v4, 4, v1
    v_lshlrev_b32 v5, 4, v1
    v_mov_b32 v6, 0x40000000
    v_mov_b32 v8, 0x3f803f80
    v_mov_b32 v9, 0x3f803f80
    v_mov_b32 v10, 0x3f803f80
    v_mov_b32 v11, 0x3f803f80
    v_cmp_eq_u32 s[40:41], 3, v4
    s_and_b32 s46, s3, 1
    s_lshr_b32 s47, s3, 1
    v_lshrrev_b32 v7, 2, v3
    v_lshl_add_u32 v7, v4, 2, v7
    v_lshlrev_b32 v7, 6, v7
    v_and_b32 v12, 3, v3
    v_lshl_add_u32 v7, v12, 3, v7
    s_lshl_b32 s48, s46, 5
    v_add_u32 v7, s48, v7
    v_lshrrev_b32 v13, 2, v1
    v_and_b32 v14, 3, v1
    v_lshlrev_b32 v14, 4, v14
    s_waitcnt lgkmcnt(0)
    s_mov_b32 s24, s20
    s_and_b32 s25, s21, 0xffff
    s_mov_b32 s26, 0x24e0000
    s_mov_b32 s27, 0x20000
    v_lshlrev_b32 v15, 19, v1
    s_lshl_b32 s58, s3, 17
    buffer_load_dword v164, v15, s[24:27], s58 offen
    s_cmp_lt_u32 s2, 112
    s_cbranch_scc1 prep_wgu
    s_cmp_lt_u32 s2, 160
    s_cbranch_scc1 prep_wqkv
    s_cmp_lt_u32 s2, 216
    s_cbranch_scc1 prep_wd
    s_cmp_lt_u32 s2, 230
    s_cbranch_scc1 prep_wo
    s_cmp_lt_u32 s2, 262
    s_cbranch_scc1 prep_x
    s_cmp_lt_u32 s2, 263
    s_cbranch_scc1 prep_wphi
    s_branch prep_zero
prep_wgu:
    s_nop 7
    s_nop 7
    s_lshr_b32 s32, s2, 4
    s_lshl_b32 s32, s32, 3
    s_and_b32 s33, s2, 7
    s_add_u32 s32, s32, s33
    s_and_b32 s34, s32, 1
    s_lshr_b32 s32, s32, 1
    s_lshl_b32 s32, s32, 1
    s_bfe_u32 s33, s2, 0x10003
    s_add_u32 s32, s32, s33
    s_cmp_eq_u32 s34, 0
    s_cselect_b32 s44, s14, s16
    s_cselect_b32 s45, s15, s17
    s_mov_b32 s28, s44
    s_and_b32 s29, s45, 0xffff
    s_mov_b32 s30, 0x188000
    s_mov_b32 s31, 0x20000
    s_lshl_b32 s35, s32, 6
    v_mul_u32_u24 v16, 3584, v13
    v_add_u32 v16, v16, v14
    s_mul_i32 s36, s3, 401408
    s_add_u32 s36, s36, s35
    s_mul_i32 s37, s3, 7168
    s_mov_b32 m0, s37
    s_nop 0
    buffer_load_dwordx4 v16, s[28:31], s36 offen lds
    s_add_u32 s36, s36, 57344
    s_add_u32 s37, s37, 1024
    s_mov_b32 m0, s37
    s_nop 0
    buffer_load_dwordx4 v16, s[28:31], s36 offen lds
    s_add_u32 s36, s36, 57344
    s_add_u32 s37, s37, 1024
    s_mov_b32 m0, s37
    s_nop 0
    buffer_load_dwordx4 v16, s[28:31], s36 offen lds
    s_add_u32 s36, s36, 57344
    s_add_u32 s37, s37, 1024
    s_mov_b32 m0, s37
    s_nop 0
    buffer_load_dwordx4 v16, s[28:31], s36 offen lds
    s_add_u32 s36, s36, 57344
    s_add_u32 s37, s37, 1024
    s_mov_b32 m0, s37
    s_nop 0
    buffer_load_dwordx4 v16, s[28:31], s36 offen lds
    s_add_u32 s36, s36, 57344
    s_add_u32 s37, s37, 1024
    s_mov_b32 m0, s37
    s_nop 0
    buffer_load_dwordx4 v16, s[28:31], s36 offen lds
    s_add_u32 s36, s36, 57344
    s_add_u32 s37, s37, 1024
    s_mov_b32 m0, s37
    s_nop 0
    buffer_load_dwordx4 v16, s[28:31], s36 offen lds
    s_waitcnt vmcnt(0)
    s_barrier
    s_mul_i32 s36, s47, 14336
    v_add_u32 v17, s36, v7
    ds_read_b64_tr_b16 v[32:33], v17 offset:0
    ds_read_b64_tr_b16 v[34:35], v17 offset:1024
    ds_read_b64_tr_b16 v[36:37], v17 offset:2048
    ds_read_b64_tr_b16 v[38:39], v17 offset:3072
    ds_read_b64_tr_b16 v[40:41], v17 offset:4096
    ds_read_b64_tr_b16 v[42:43], v17 offset:5120
    ds_read_b64_tr_b16 v[44:45], v17 offset:6144
    ds_read_b64_tr_b16 v[46:47], v17 offset:7168
    ds_read_b64_tr_b16 v[48:49], v17 offset:8192
    ds_read_b64_tr_b16 v[50:51], v17 offset:9216
    ds_read_b64_tr_b16 v[52:53], v17 offset:10240
    ds_read_b64_tr_b16 v[54:55], v17 offset:11264
    ds_read_b64_tr_b16 v[56:57], v17 offset:12288
    ds_read_b64_tr_b16 v[58:59], v17 offset:13312
    s_waitcnt lgkmcnt(0)
    s_lshl_b32 s33, s32, 1
    s_add_u32 s33, s33, s46
    s_mul_i32 s39, s33, 14
    s_mul_i32 s38, s47, 7
    s_add_u32 s39, s39, s38
    s_lshl_b32 s39, s39, 1
    s_add_u32 s39, s39, s34
    s_lshl_b32 s39, s39, 10
    s_add_u32 s39, s39, 0x1e0000
    s_add_u32 s37, s39, 0x0
    buffer_store_dwordx4 v[32:35], v5, s[24:27], s37 offen
    s_add_u32 s37, s39, 0x800
    buffer_store_dwordx4 v[36:39], v5, s[24:27], s37 offen
    s_add_u32 s37, s39, 0x1000
    buffer_store_dwordx4 v[40:43], v5, s[24:27], s37 offen
    s_add_u32 s37, s39, 0x1800
    buffer_store_dwordx4 v[44:47], v5, s[24:27], s37 offen
    s_add_u32 s37, s39, 0x2000
    buffer_store_dwordx4 v[48:51], v5, s[24:27], s37 offen
    s_add_u32 s37, s39, 0x2800
    buffer_store_dwordx4 v[52:55], v5, s[24:27], s37 offen
    s_add_u32 s37, s39, 0x3000
    buffer_store_dwordx4 v[56:59], v5, s[24:27], s37 offen
    s_lshl_b32 s42, s33, 1
    s_add_u32 s42, s42, s34
    s_lshl_b32 s42, s42, 10
    s_add_u32 s42, s42, 0x4f0000
    v_mfma_f32_16x16x32_bf16 v[16:19], v[32:35], v[8:11], 0
    v_mfma_f32_16x16x32_bf16 v[16:19], v[36:39], v[8:11], v[16:19]
    v_mfma_f32_16x16x32_bf16 v[16:19], v[40:43], v[8:11], v[16:19]
    v_mfma_f32_16x16x32_bf16 v[16:19], v[44:47], v[8:11], v[16:19]
    v_mfma_f32_16x16x32_bf16 v[16:19], v[48:51], v[8:11], v[16:19]
    v_mfma_f32_16x16x32_bf16 v[16:19], v[52:55], v[8:11], v[16:19]
    v_mfma_f32_16x16x32_bf16 v[16:19], v[56:59], v[8:11], v[16:19]
    s_lshl_b32 s36, s46, 10
    s_add_u32 s36, s36, 29696
    v_add_u32 v20, s36, v5
    s_cmp_eq_u32 s47, 0
    s_cbranch_scc1 prep_cs0_gu
    s_nop 2
    ds_write_b128 v20, v[16:19]
    s_waitcnt lgkmcnt(0)
    s_barrier
    s_branch prep_done
prep_cs0_gu:
    s_nop 7
    s_nop 7
    s_barrier
    ds_read_b128 v[20:23], v20
    s_waitcnt lgkmcnt(0)
    v_add_f32 v16, v16, v20
    v_add_f32 v17, v17, v21
    v_add_f32 v18, v18, v22
    v_add_f32 v19, v19, v23
    buffer_store_dwordx4 v[16:19], v5, s[24:27], s42 offen
    s_branch prep_done
prep_wqkv:
    s_nop 7
    s_nop 7
    s_mov_b32 s28, s6
    s_and_b32 s29, s7, 0xffff
    s_mov_b32 s30, 0x126000
    s_mov_b32 s31, 0x20000
    s_sub_u32 s32, s2, 112
    s_lshr_b32 s33, s32, 4
    s_and_b32 s34, s32, 15
    s_mul_i32 s35, s33, 896
    s_mul_i32 s38, s34, 56
    s_add_u32 s35, s35, s38
    v_mul_u32_u24 v16, 2688, v13
    v_add_u32 v16, v16, v14
    s_mul_i32 s36, s3, 301056
    s_add_u32 s36, s36, s35
    s_mul_i32 s37, s3, 7168
    s_mov_b32 m0, s37
    s_nop 0
    buffer_load_dwordx4 v16, s[28:31], s36 offen lds
    s_add_u32 s36, s36, 43008
    s_add_u32 s37, s37, 1024
    s_mov_b32 m0, s37
    s_nop 0
    buffer_load_dwordx4 v16, s[28:31], s36 offen lds
    s_add_u32 s36, s36, 43008
    s_add_u32 s37, s37, 1024
    s_mov_b32 m0, s37
    s_nop 0
    buffer_load_dwordx4 v16, s[28:31], s36 offen lds
    s_add_u32 s36, s36, 43008
    s_add_u32 s37, s37, 1024
    s_mov_b32 m0, s37
    s_nop 0
    buffer_load_dwordx4 v16, s[28:31], s36 offen lds
    s_add_u32 s36, s36, 43008
    s_add_u32 s37, s37, 1024
    s_mov_b32 m0, s37
    s_nop 0
    buffer_load_dwordx4 v16, s[28:31], s36 offen lds
    s_add_u32 s36, s36, 43008
    s_add_u32 s37, s37, 1024
    s_mov_b32 m0, s37
    s_nop 0
    buffer_load_dwordx4 v16, s[28:31], s36 offen lds
    s_add_u32 s36, s36, 43008
    s_add_u32 s37, s37, 1024
    s_mov_b32 m0, s37
    s_nop 0
    buffer_load_dwordx4 v16, s[28:31], s36 offen lds
    s_waitcnt vmcnt(0)
    s_barrier
    s_mul_i32 s36, s47, 14336
    v_add_u32 v17, s36, v7
    ds_read_b64_tr_b16 v[32:33], v17 offset:0
    ds_read_b64_tr_b16 v[34:35], v17 offset:1024
    ds_read_b64_tr_b16 v[36:37], v17 offset:2048
    ds_read_b64_tr_b16 v[38:39], v17 offset:3072
    ds_read_b64_tr_b16 v[40:41], v17 offset:4096
    ds_read_b64_tr_b16 v[42:43], v17 offset:5120
    ds_read_b64_tr_b16 v[44:45], v17 offset:6144
    ds_read_b64_tr_b16 v[46:47], v17 offset:7168
    ds_read_b64_tr_b16 v[48:49], v17 offset:8192
    ds_read_b64_tr_b16 v[50:51], v17 offset:9216
    ds_read_b64_tr_b16 v[52:53], v17 offset:10240
    ds_read_b64_tr_b16 v[54:55], v17 offset:11264
    ds_read_b64_tr_b16 v[56:57], v17 offset:12288
    ds_read_b64_tr_b16 v[58:59], v17 offset:13312
    s_waitcnt lgkmcnt(0)
    s_mul_i32 s38, s46, 4
    s_sub_u32 s38, 16, s38
    v_cmp_gt_u32 vcc, s38, v3
    s_nop 1
    v_cndmask_b32 v32, 0, v32, vcc
    v_cndmask_b32 v33, 0, v33, vcc
    v_cndmask_b32 v34, 0, v34, vcc
    v_cndmask_b32 v35, 0, v35, vcc
    v_cndmask_b32 v36, 0, v36, vcc
    v_cndmask_b32 v37, 0, v37, vcc
    v_cndmask_b32 v38, 0, v38, vcc
    v_cndmask_b32 v39, 0, v39, vcc
    v_cndmask_b32 v40, 0, v40, vcc
    v_cndmask_b32 v41, 0, v41, vcc
    v_cndmask_b32 v42, 0, v42, vcc
    v_cndmask_b32 v43, 0, v43, vcc
    v_cndmask_b32 v44, 0, v44, vcc
    v_cndmask_b32 v45, 0, v45, vcc
    v_cndmask_b32 v46, 0, v46, vcc
    v_cndmask_b32 v47, 0, v47, vcc
    v_cndmask_b32 v48, 0, v48, vcc
    v_cndmask_b32 v49, 0, v49, vcc
    v_cndmask_b32 v50, 0, v50, vcc
    v_cndmask_b32 v51, 0, v51, vcc
    v_cndmask_b32 v52, 0, v52, vcc
    v_cndmask_b32 v53, 0, v53, vcc
    v_cndmask_b32 v54, 0, v54, vcc
    v_cndmask_b32 v55, 0, v55, vcc
    v_cndmask_b32 v56, 0, v56, vcc
    v_cndmask_b32 v57, 0, v57, vcc
    v_cndmask_b32 v58, 0, v58, vcc
    v_cndmask_b32 v59, 0, v59, vcc
    s_lshl_b32 s33, s33, 1
    s_add_u32 s33, s33, s46
    s_mul_i32 s39, s34, 14
    s_mul_i32 s38, s47, 7
    s_add_u32 s39, s39, s38
    s_mul_i32 s39, s39, 6
    s_add_u32 s39, s39, s33
    s_lshl_b32 s39, s39, 10
    s_add_u32 s39, s39, 0x0
    s_add_u32 s37, s39, 0x0
    buffer_store_dwordx4 v[32:35], v5, s[24:27], s37 offen
    s_add_u32 s37, s39, 0x1800
    buffer_store_dwordx4 v[36:39], v5, s[24:27], s37 offen
    s_add_u32 s37, s39, 0x3000
    buffer_store_dwordx4 v[40:43], v5, s[24:27], s37 offen
    s_add_u32 s37, s39, 0x4800
    buffer_store_dwordx4 v[44:47], v5, s[24:27], s37 offen
    s_add_u32 s37, s39, 0x6000
    buffer_store_dwordx4 v[48:51], v5, s[24:27], s37 offen
    s_add_u32 s37, s39, 0x7800
    buffer_store_dwordx4 v[52:55], v5, s[24:27], s37 offen
    s_add_u32 s37, s39, 0x9000
    buffer_store_dwordx4 v[56:59], v5, s[24:27], s37 offen
    s_mul_i32 s42, s34, 6
    s_add_u32 s42, s42, s33
    s_lshl_b32 s42, s42, 10
    s_add_u32 s42, s42, 0x150000
    v_mfma_f32_16x16x32_bf16 v[16:19], v[32:35], v[8:11], 0
    v_mfma_f32_16x16x32_bf16 v[16:19], v[36:39], v[8:11], v[16:19]
    v_mfma_f32_16x16x32_bf16 v[16:19], v[40:43], v[8:11], v[16:19]
    v_mfma_f32_16x16x32_bf16 v[16:19], v[44:47], v[8:11], v[16:19]
    v_mfma_f32_16x16x32_bf16 v[16:19], v[48:51], v[8:11], v[16:19]
    v_mfma_f32_16x16x32_bf16 v[16:19], v[52:55], v[8:11], v[16:19]
    v_mfma_f32_16x16x32_bf16 v[16:19], v[56:59], v[8:11], v[16:19]
    s_lshl_b32 s36, s46, 10
    s_add_u32 s36, s36, 29696
    v_add_u32 v20, s36, v5
    s_cmp_eq_u32 s47, 0
    s_cbranch_scc1 prep_cs0_qkv
    s_nop 2
    ds_write_b128 v20, v[16:19]
    s_waitcnt lgkmcnt(0)
    s_barrier
    s_branch prep_done
prep_cs0_qkv:
    s_nop 7
    s_nop 7
    s_barrier
    ds_read_b128 v[20:23], v20
    s_waitcnt lgkmcnt(0)
    v_add_f32 v16, v16, v20
    v_add_f32 v17, v17, v21
    v_add_f32 v18, v18, v22
    v_add_f32 v19, v19, v23
    buffer_store_dwordx4 v[16:19], v5, s[24:27], s42 offen
    s_branch prep_done
prep_wd:
    s_nop 7
    s_nop 7
    s_mov_b32 s28, s18
    s_and_b32 s29, s19, 0xffff
    s_mov_b32 s30, 0x188000
    s_mov_b32 s31, 0x20000
    s_sub_u32 s32, s2, 160
    s_and_b32 s34, s32, 3
    s_lshr_b32 s32, s32, 2
    s_mul_i32 s35, s34, 401408
    s_lshl_b32 s38, s32, 6
    s_add_u32 s35, s35, s38
    v_mul_u32_u24 v16, 896, v13
    v_add_u32 v16, v16, v14
    s_mul_i32 s36, s3, 100352
    s_add_u32 s36, s36, s35
    s_mul_i32 s37, s3, 7168
    s_mov_b32 m0, s37
    s_nop 0
    buffer_load_dwordx4 v16, s[28:31], s36 offen lds
    s_add_u32 s36, s36, 14336
    s_add_u32 s37, s37, 1024
    s_mov_b32 m0, s37
    s_nop 0
    buffer_load_dwordx4 v16, s[28:31], s36 offen lds
    s_add_u32 s36, s36, 14336
    s_add_u32 s37, s37, 1024
    s_mov_b32 m0, s37
    s_nop 0
    buffer_load_dwordx4 v16, s[28:31], s36 offen lds
    s_add_u32 s36, s36, 14336
    s_add_u32 s37, s37, 1024
    s_mov_b32 m0, s37
    s_nop 0
    buffer_load_dwordx4 v16, s[28:31], s36 offen lds
    s_add_u32 s36, s36, 14336
    s_add_u32 s37, s37, 1024
    s_mov_b32 m0, s37
    s_nop 0
    buffer_load_dwordx4 v16, s[28:31], s36 offen lds
    s_add_u32 s36, s36, 14336
    s_add_u32 s37, s37, 1024
    s_mov_b32 m0, s37
    s_nop 0
    buffer_load_dwordx4 v16, s[28:31], s36 offen lds
    s_add_u32 s36, s36, 14336
    s_add_u32 s37, s37, 1024
    s_mov_b32 m0, s37
    s_nop 0
    buffer_load_dwordx4 v16, s[28:31], s36 offen lds
    s_waitcnt vmcnt(0)
    s_barrier
    s_mul_i32 s36, s47, 14336
    v_add_u32 v17, s36, v7
    ds_read_b64_tr_b16 v[32:33], v17 offset:0
    ds_read_b64_tr_b16 v[34:35], v17 offset:1024
    ds_read_b64_tr_b16 v[36:37], v17 offset:2048
    ds_read_b64_tr_b16 v[38:39], v17 offset:3072
    ds_read_b64_tr_b16 v[40:41], v17 offset:4096
    ds_read_b64_tr_b16 v[42:43], v17 offset:5120
    ds_read_b64_tr_b16 v[44:45], v17 offset:6144
    ds_read_b64_tr_b16 v[46:47], v17 offset:7168
    ds_read_b64_tr_b16 v[48:49], v17 offset:8192
    ds_read_b64_tr_b16 v[50:51], v17 offset:9216
    ds_read_b64_tr_b16 v[52:53], v17 offset:10240
    ds_read_b64_tr_b16 v[54:55], v17 offset:11264
    ds_read_b64_tr_b16 v[56:57], v17 offset:12288
    ds_read_b64_tr_b16 v[58:59], v17 offset:13312
    s_waitcnt lgkmcnt(0)
    s_lshl_b32 s33, s32, 1
    s_add_u32 s33, s33, s46
    s_mul_i32 s39, s33, 56
    s_mul_i32 s38, s34, 14
    s_add_u32 s39, s39, s38
    s_mul_i32 s38, s47, 7
    s_add_u32 s39, s39, s38
    s_lshl_b32 s39, s39, 10
    s_add_u32 s39, s39, 0x528000
    s_add_u32 s37, s39, 0x0
    buffer_store_dwordx4 v[32:35], v5, s[24:27], s37 offen
    s_add_u32 s37, s39, 0x400
    buffer_store_dwordx4 v[36:39], v5, s[24:27], s37 offen
    s_add_u32 s37, s39, 0x800
    buffer_store_dwordx4 v[40:43], v5, s[24:27], s37 offen
    s_add_u32 s37, s39, 0xc00
    buffer_store_dwordx4 v[44:47], v5, s[24:27], s37 offen
    s_add_u32 s37, s39, 0x1000
    buffer_store_dwordx4 v[48:51], v5, s[24:27], s37 offen
    s_add_u32 s37, s39, 0x1400
    buffer_store_dwordx4 v[52:55], v5, s[24:27], s37 offen
    s_add_u32 s37, s39, 0x1800
    buffer_store_dwordx4 v[56:59], v5, s[24:27], s37 offen
    s_branch prep_done
prep_wo:
    s_nop 7
    s_nop 7
    s_mov_b32 s28, s10
    s_and_b32 s29, s11, 0xffff
    s_mov_b32 s30, 0x62000
    s_mov_b32 s31, 0x20000
    s_sub_u32 s32, s2, 216
    s_lshl_b32 s35, s32, 6
    v_mul_u32_u24 v16, 896, v13
    v_add_u32 v16, v16, v14
    s_mul_i32 s36, s3, 100352
    s_add_u32 s36, s36, s35
    s_mul_i32 s37, s3, 7168
    s_mov_b32 m0, s37
    s_nop 0
    buffer_load_dwordx4 v16, s[28:31], s36 offen lds
    s_add_u32 s36, s36, 14336
    s_add_u32 s37, s37, 1024
    s_mov_b32 m0, s37
    s_nop 0
    buffer_load_dwordx4 v16, s[28:31], s36 offen lds
    s_add_u32 s36, s36, 14336
    s_add_u32 s37, s37, 1024
    s_mov_b32 m0, s37
    s_nop 0
    buffer_load_dwordx4 v16, s[28:31], s36 offen lds
    s_add_u32 s36, s36, 14336
    s_add_u32 s37, s37, 1024
    s_mov_b32 m0, s37
    s_nop 0
    buffer_load_dwordx4 v16, s[28:31], s36 offen lds
    s_add_u32 s36, s36, 14336
    s_add_u32 s37, s37, 1024
    s_mov_b32 m0, s37
    s_nop 0
    buffer_load_dwordx4 v16, s[28:31], s36 offen lds
    s_add_u32 s36, s36, 14336
    s_add_u32 s37, s37, 1024
    s_mov_b32 m0, s37
    s_nop 0
    buffer_load_dwordx4 v16, s[28:31], s36 offen lds
    s_add_u32 s36, s36, 14336
    s_add_u32 s37, s37, 1024
    s_mov_b32 m0, s37
    s_nop 0
    buffer_load_dwordx4 v16, s[28:31], s36 offen lds
    s_waitcnt vmcnt(0)
    s_barrier
    s_mul_i32 s36, s47, 14336
    v_add_u32 v17, s36, v7
    ds_read_b64_tr_b16 v[32:33], v17 offset:0
    ds_read_b64_tr_b16 v[34:35], v17 offset:1024
    ds_read_b64_tr_b16 v[36:37], v17 offset:1792
    ds_read_b64_tr_b16 v[38:39], v17 offset:2816
    ds_read_b64_tr_b16 v[40:41], v17 offset:3584
    ds_read_b64_tr_b16 v[42:43], v17 offset:4608
    ds_read_b64_tr_b16 v[44:45], v17 offset:5376
    ds_read_b64_tr_b16 v[46:47], v17 offset:6400
    ds_read_b64_tr_b16 v[48:49], v17 offset:7168
    ds_read_b64_tr_b16 v[50:51], v17 offset:8192
    ds_read_b64_tr_b16 v[52:53], v17 offset:8960
    ds_read_b64_tr_b16 v[54:55], v17 offset:9984
    ds_read_b64_tr_b16 v[56:57], v17 offset:10752
    ds_read_b64_tr_b16 v[58:59], v17 offset:11776
    ds_read_b64_tr_b16 v[60:61], v17 offset:12544
    ds_read_b64_tr_b16 v[62:63], v17 offset:13568
    s_waitcnt lgkmcnt(0)
    v_cndmask_b32 v34, v34, 0, s[40:41]
    v_cndmask_b32 v35, v35, 0, s[40:41]
    v_cndmask_b32 v38, v38, 0, s[40:41]
    v_cndmask_b32 v39, v39, 0, s[40:41]
    v_cndmask_b32 v42, v42, 0, s[40:41]
    v_cndmask_b32 v43, v43, 0, s[40:41]
    v_cndmask_b32 v46, v46, 0, s[40:41]
    v_cndmask_b32 v47, v47, 0, s[40:41]
    v_cndmask_b32 v50, v50, 0, s[40:41]
    v_cndmask_b32 v51, v51, 0, s[40:41]
    v_cndmask_b32 v54, v54, 0, s[40:41]
    v_cndmask_b32 v55, v55, 0, s[40:41]
    v_cndmask_b32 v58, v58, 0, s[40:41]
    v_cndmask_b32 v59, v59, 0, s[40:41]
    v_cndmask_b32 v62, v62, 0, s[40:41]
    v_cndmask_b32 v63, v63, 0, s[40:41]
    s_lshl_b32 s33, s32, 1
    s_add_u32 s33, s33, s46
    s_mul_i32 s39, s47, 224
    s_add_u32 s39, s39, s33
    s_lshl_b32 s39, s39, 10
    s_add_u32 s39, s39, 0x170000
    s_add_u32 s37, s39, 0x0
    buffer_store_dwordx4 v[32:35], v5, s[24:27], s37 offen
    s_add_u32 s37, s39, 0x7000
    buffer_store_dwordx4 v[36:39], v5, s[24:27], s37 offen
    s_add_u32 s37, s39, 0xe000
    buffer_store_dwordx4 v[40:43], v5, s[24:27], s37 offen
    s_add_u32 s37, s39, 0x15000
    buffer_store_dwordx4 v[44:47], v5, s[24:27], s37 offen
    s_add_u32 s37, s39, 0x1c000
    buffer_store_dwordx4 v[48:51], v5, s[24:27], s37 offen
    s_add_u32 s37, s39, 0x23000
    buffer_store_dwordx4 v[52:55], v5, s[24:27], s37 offen
    s_add_u32 s37, s39, 0x2a000
    buffer_store_dwordx4 v[56:59], v5, s[24:27], s37 offen
    s_add_u32 s37, s39, 0x31000
    buffer_store_dwordx4 v[60:63], v5, s[24:27], s37 offen
    s_branch prep_done
prep_wphi:
    s_nop 7
    s_nop 7
    s_mov_b32 s28, s8
    s_and_b32 s29, s9, 0xffff
    s_mov_b32 s30, 0x6200
    s_mov_b32 s31, 0x20000
    s_mul_i32 s35, s3, 6272
    v_lshlrev_b32 v16, 1, v3
    v_mul_u32_u24 v17, 224, v4
    v_add_u32 v16, v16, v17
    v_add_u32 v16, s35, v16
    v_cndmask_b32 v18, v16, v6, s[40:41]
    v_add_u32 v19, 32, v16
    v_cmp_gt_u32 vcc, 12, v3
    s_nop 1
    v_cndmask_b32 v19, v6, v19, vcc
    v_cndmask_b32 v20, v19, v6, s[40:41]
    s_mov_b32 s36, 0x0
    buffer_load_ushort v100, v16, s[28:31], s36 offen
    s_mov_b32 s36, 0x38
    buffer_load_ushort v101, v16, s[28:31], s36 offen
    s_mov_b32 s36, 0x70
    buffer_load_ushort v102, v16, s[28:31], s36 offen
    s_mov_b32 s36, 0xa8
    buffer_load_ushort v103, v16, s[28:31], s36 offen
    s_mov_b32 s36, 0x380
    buffer_load_ushort v104, v18, s[28:31], s36 offen
    s_mov_b32 s36, 0x3b8
    buffer_load_ushort v105, v18, s[28:31], s36 offen
    s_mov_b32 s36, 0x3f0
    buffer_load_ushort v106, v18, s[28:31], s36 offen
    s_mov_b32 s36, 0x428
    buffer_load_ushort v107, v18, s[28:31], s36 offen
    s_mov_b32 s36, 0x0
    buffer_load_ushort v108, v19, s[28:31], s36 offen
    s_mov_b32 s36, 0x38
    buffer_load_ushort v109, v19, s[28:31], s36 offen
    s_mov_b32 s36, 0x70
    buffer_load_ushort v110, v19, s[28:31], s36 offen
    s_mov_b32 s36, 0xa8
    buffer_load_ushort v111, v19, s[28:31], s36 offen
    s_mov_b32 s36, 0x380
    buffer_load_ushort v112, v20, s[28:31], s36 offen
    s_mov_b32 s36, 0x3b8
    buffer_load_ushort v113, v20, s[28:31], s36 offen
    s_mov_b32 s36, 0x3f0
    buffer_load_ushort v114, v20, s[28:31], s36 offen
    s_mov_b32 s36, 0x428
    buffer_load_ushort v115, v20, s[28:31], s36 offen
    s_mov_b32 s36, 0x620
    buffer_load_ushort v116, v16, s[28:31], s36 offen
    s_mov_b32 s36, 0x658
    buffer_load_ushort v117, v16, s[28:31], s36 offen
    s_mov_b32 s36, 0x690
    buffer_load_ushort v118, v16, s[28:31], s36 offen
    s_mov_b32 s36, 0x6c8
    buffer_load_ushort v119, v16, s[28:31], s36 offen
    s_mov_b32 s36, 0x9a0
    buffer_load_ushort v120, v18, s[28:31], s36 offen
    s_mov_b32 s36, 0x9d8
    buffer_load_ushort v121, v18, s[28:31], s36 offen
    s_mov_b32 s36, 0xa10
    buffer_load_ushort v122, v18, s[28:31], s36 offen
    s_mov_b32 s36, 0xa48
    buffer_load_ushort v123, v18, s[28:31], s36 offen
    s_mov_b32 s36, 0x620
    buffer_load_ushort v124, v19, s[28:31], s36 offen
    s_mov_b32 s36, 0x658
    buffer_load_ushort v125, v19, s[28:31], s36 offen
    s_mov_b32 s36, 0x690
    buffer_load_ushort v126, v19, s[28:31], s36 offen
    s_mov_b32 s36, 0x6c8
    buffer_load_ushort v127, v19, s[28:31], s36 offen
    s_mov_b32 s36, 0x9a0
    buffer_load_ushort v128, v20, s[28:31], s36 offen
    s_mov_b32 s36, 0x9d8
    buffer_load_ushort v129, v20, s[28:31], s36 offen
    s_mov_b32 s36, 0xa10
    buffer_load_ushort v130, v20, s[28:31], s36 offen
    s_mov_b32 s36, 0xa48
    buffer_load_ushort v131, v20, s[28:31], s36 offen
    s_mov_b32 s36, 0xc40
    buffer_load_ushort v132, v16, s[28:31], s36 offen
    s_mov_b32 s36, 0xc78
    buffer_load_ushort v133, v16, s[28:31], s36 offen
    s_mov_b32 s36, 0xcb0
    buffer_load_ushort v134, v16, s[28:31], s36 offen
    s_mov_b32 s36, 0xce8
    buffer_load_ushort v135, v16, s[28:31], s36 offen
    s_mov_b32 s36, 0xfc0
    buffer_load_ushort v136, v18, s[28:31], s36 offen
    s_mov_b32 s36, 0xff8
    buffer_load_ushort v137, v18, s[28:31], s36 offen
    s_mov_b32 s36, 0x1030
    buffer_load_ushort v138, v18, s[28:31], s36 offen
    s_mov_b32 s36, 0x1068
    buffer_load_ushort v139, v18, s[28:31], s36 offen
    s_mov_b32 s36, 0xc40
    buffer_load_ushort v140, v19, s[28:31], s36 offen
    s_mov_b32 s36, 0xc78
    buffer_load_ushort v141, v19, s[28:31], s36 offen
    s_mov_b32 s36, 0xcb0
    buffer_load_ushort v142, v19, s[28:31], s36 offen
    s_mov_b32 s36, 0xce8
    buffer_load_ushort v143, v19, s[28:31], s36 offen
    s_mov_b32 s36, 0xfc0
    buffer_load_ushort v144, v20, s[28:31], s36 offen
    s_mov_b32 s36, 0xff8
    buffer_load_ushort v145, v20, s[28:31], s36 offen
    s_mov_b32 s36, 0x1030
    buffer_load_ushort v146, v20, s[28:31], s36 offen
    s_mov_b32 s36, 0x1068
    buffer_load_ushort v147, v20, s[28:31], s36 offen
    s_mov_b32 s36, 0x1260
    buffer_load_ushort v148, v16, s[28:31], s36 offen
    s_mov_b32 s36, 0x1298
    buffer_load_ushort v149, v16, s[28:31], s36 offen
    s_mov_b32 s36, 0x12d0
    buffer_load_ushort v150, v16, s[28:31], s36 offen
    s_mov_b32 s36, 0x1308
    buffer_load_ushort v151, v16, s[28:31], s36 offen
    s_mov_b32 s36, 0x15e0
    buffer_load_ushort v152, v18, s[28:31], s36 offen
    s_mov_b32 s36, 0x1618
    buffer_load_ushort v153, v18, s[28:31], s36 offen
    s_mov_b32 s36, 0x1650
    buffer_load_ushort v154, v18, s[28:31], s36 offen
    s_mov_b32 s36, 0x1688
    buffer_load_ushort v155, v18, s[28:31], s36 offen
    s_mov_b32 s36, 0x1260
    buffer_load_ushort v156, v19, s[28:31], s36 offen
    s_mov_b32 s36, 0x1298
    buffer_load_ushort v157, v19, s[28:31], s36 offen
    s_mov_b32 s36, 0x12d0
    buffer_load_ushort v158, v19, s[28:31], s36 offen
    s_mov_b32 s36, 0x1308
    buffer_load_ushort v159, v19, s[28:31], s36 offen
    s_mov_b32 s36, 0x15e0
    buffer_load_ushort v160, v20, s[28:31], s36 offen
    s_mov_b32 s36, 0x1618
    buffer_load_ushort v161, v20, s[28:31], s36 offen
    s_mov_b32 s36, 0x1650
    buffer_load_ushort v162, v20, s[28:31], s36 offen
    s_mov_b32 s36, 0x1688
    buffer_load_ushort v163, v20, s[28:31], s36 offen
    s_lshl_b32 s39, s3, 13
    s_add_u32 s39, s39, 0x168000
    s_waitcnt vmcnt(0)
    v_lshl_or_b32 v32, v101, 16, v100
    v_lshl_or_b32 v33, v103, 16, v102
    v_lshl_or_b32 v34, v105, 16, v104
    v_lshl_or_b32 v35, v107, 16, v106
    v_lshl_or_b32 v36, v109, 16, v108
    v_lshl_or_b32 v37, v111, 16, v110
    v_lshl_or_b32 v38, v113, 16, v112
    v_lshl_or_b32 v39, v115, 16, v114
    v_lshl_or_b32 v40, v117, 16, v116
    v_lshl_or_b32 v41, v119, 16, v118
    v_lshl_or_b32 v42, v121, 16, v120
    v_lshl_or_b32 v43, v123, 16, v122
    v_lshl_or_b32 v44, v125, 16, v124
    v_lshl_or_b32 v45, v127, 16, v126
    v_lshl_or_b32 v46, v129, 16, v128
    v_lshl_or_b32 v47, v131, 16, v130
    v_lshl_or_b32 v48, v133, 16, v132
    v_lshl_or_b32 v49, v135, 16, v134
    v_lshl_or_b32 v50, v137, 16, v136
    v_lshl_or_b32 v51, v139, 16, v138
    v_lshl_or_b32 v52, v141, 16, v140
    v_lshl_or_b32 v53, v143, 16, v142
    v_lshl_or_b32 v54, v145, 16, v144
    v_lshl_or_b32 v55, v147, 16, v146
    v_lshl_or_b32 v56, v149, 16, v148
    v_lshl_or_b32 v57, v151, 16, v150
    v_lshl_or_b32 v58, v153, 16, v152
    v_lshl_or_b32 v59, v155, 16, v154
    v_lshl_or_b32 v60, v157, 16, v156
    v_lshl_or_b32 v61, v159, 16, v158
    v_lshl_or_b32 v62, v161, 16, v160
    v_lshl_or_b32 v63, v163, 16, v162
    s_add_u32 s37, s39, 0x0
    buffer_store_dwordx4 v[32:35], v5, s[24:27], s37 offen
    s_add_u32 s37, s39, 0x400
    buffer_store_dwordx4 v[36:39], v5, s[24:27], s37 offen
    s_add_u32 s37, s39, 0x800
    buffer_store_dwordx4 v[40:43], v5, s[24:27], s37 offen
    s_add_u32 s37, s39, 0xc00
    buffer_store_dwordx4 v[44:47], v5, s[24:27], s37 offen
    s_add_u32 s37, s39, 0x1000
    buffer_store_dwordx4 v[48:51], v5, s[24:27], s37 offen
    s_add_u32 s37, s39, 0x1400
    buffer_store_dwordx4 v[52:55], v5, s[24:27], s37 offen
    s_add_u32 s37, s39, 0x1800
    buffer_store_dwordx4 v[56:59], v5, s[24:27], s37 offen
    s_add_u32 s37, s39, 0x1c00
    buffer_store_dwordx4 v[60:63], v5, s[24:27], s37 offen
    s_branch prep_done
prep_zero:
    s_nop 7
    s_nop 7
    s_sub_u32 s32, s2, 263
    s_lshl_b32 s39, s32, 16
    s_add_u32 s39, s39, 0x6b0000
    v_lshlrev_b32 v16, 4, v0
    v_mov_b32 v20, 0
    v_mov_b32 v21, 0
    v_mov_b32 v22, 0
    v_mov_b32 v23, 0
    s_add_u32 s37, s39, 0x0
    buffer_store_dwordx4 v[20:23], v16, s[24:27], s37 offen
    s_add_u32 s37, s39, 0x1000
    buffer_store_dwordx4 v[20:23], v16, s[24:27], s37 offen
    s_add_u32 s37, s39, 0x2000
    buffer_store_dwordx4 v[20:23], v16, s[24:27], s37 offen
    s_add_u32 s37, s39, 0x3000
    buffer_store_dwordx4 v[20:23], v16, s[24:27], s37 offen
    s_add_u32 s37, s39, 0x4000
    buffer_store_dwordx4 v[20:23], v16, s[24:27], s37 offen
    s_add_u32 s37, s39, 0x5000
    buffer_store_dwordx4 v[20:23], v16, s[24:27], s37 offen
    s_add_u32 s37, s39, 0x6000
    buffer_store_dwordx4 v[20:23], v16, s[24:27], s37 offen
    s_add_u32 s37, s39, 0x7000
    buffer_store_dwordx4 v[20:23], v16, s[24:27], s37 offen
    s_add_u32 s37, s39, 0x8000
    buffer_store_dwordx4 v[20:23], v16, s[24:27], s37 offen
    s_add_u32 s37, s39, 0x9000
    buffer_store_dwordx4 v[20:23], v16, s[24:27], s37 offen
    s_add_u32 s37, s39, 0xa000
    buffer_store_dwordx4 v[20:23], v16, s[24:27], s37 offen
    s_add_u32 s37, s39, 0xb000
    buffer_store_dwordx4 v[20:23], v16, s[24:27], s37 offen
    s_add_u32 s37, s39, 0xc000
    buffer_store_dwordx4 v[20:23], v16, s[24:27], s37 offen
    s_add_u32 s37, s39, 0xd000
    buffer_store_dwordx4 v[20:23], v16, s[24:27], s37 offen
    s_add_u32 s37, s39, 0xe000
    buffer_store_dwordx4 v[20:23], v16, s[24:27], s37 offen
    s_add_u32 s37, s39, 0xf000
    buffer_store_dwordx4 v[20:23], v16, s[24:27], s37 offen
    s_lshl_b32 s37, s32, 14
    s_add_u32 s37, s37, 0x24d0000
    buffer_store_dwordx4 v[20:23], v16, s[24:27], s37 offen
    s_add_u32 s37, s37, 4096
    buffer_store_dwordx4 v[20:23], v16, s[24:27], s37 offen
    s_add_u32 s37, s37, 4096
    buffer_store_dwordx4 v[20:23], v16, s[24:27], s37 offen
    s_add_u32 s37, s37, 4096
    buffer_store_dwordx4 v[20:23], v16, s[24:27], s37 offen
    s_add_u32 s37, s37, 4096
    s_branch prep_done
prep_x:
    s_nop 7
    s_nop 7
    s_mov_b32 s28, s4
    s_and_b32 s29, s5, 0xffff
    s_mov_b32 s30, 0x1c0000
    s_mov_b32 s31, 0x20000
    s_sub_u32 s32, s2, 230
    s_lshl_b32 s32, s32, 2
    s_add_u32 s32, s32, s3
    s_mul_i32 s35, s32, 14336
    s_mul_i32 s37, s3, 14336
    s_add_u32 s36, s37, 0
    s_mov_b32 m0, s36
    s_add_u32 s38, s35, 0
    buffer_load_dwordx4 v5, s[28:31], s38 offen offset:0 lds
    buffer_load_dwordx4 v5, s[28:31], s38 offen offset:1024 lds
    buffer_load_dwordx4 v5, s[28:31], s38 offen offset:2048 lds
    buffer_load_dwordx4 v5, s[28:31], s38 offen offset:3072 lds
    s_add_u32 s36, s37, 4096
    s_mov_b32 m0, s36
    s_add_u32 s38, s35, 4096
    buffer_load_dwordx4 v5, s[28:31], s38 offen offset:0 lds
    buffer_load_dwordx4 v5, s[28:31], s38 offen offset:1024 lds
    buffer_load_dwordx4 v5, s[28:31], s38 offen offset:2048 lds
    buffer_load_dwordx4 v5, s[28:31], s38 offen offset:3072 lds
    s_add_u32 s36, s37, 8192
    s_mov_b32 m0, s36
    s_add_u32 s38, s35, 8192
    buffer_load_dwordx4 v5, s[28:31], s38 offen offset:0 lds
    buffer_load_dwordx4 v5, s[28:31], s38 offen offset:1024 lds
    buffer_load_dwordx4 v5, s[28:31], s38 offen offset:2048 lds
    buffer_load_dwordx4 v5, s[28:31], s38 offen offset:3072 lds
    s_add_u32 s36, s37, 12288
    s_mov_b32 m0, s36
    s_add_u32 s38, s35, 12288
    buffer_load_dwordx4 v5, s[28:31], s38 offen offset:0 lds
    buffer_load_dwordx4 v5, s[28:31], s38 offen offset:1024 lds
    v_mul_u32_u24 v16, 896, v3
    v_lshlrev_b32 v17, 3, v4
    v_add3_u32 v16, v16, v17, s37
    s_mul_i32 s39, s32, 14336
    s_add_u32 s39, s39, 0xaf0000
    v_mov_b32 v12, 0
    v_mov_b32 v13, 0
    v_mov_b32 v14, 0
    v_mov_b32 v15, 0
    s_waitcnt vmcnt(0)
    ds_read_b64 v[32:33], v16 offset:0
    ds_read_b64 v[34:35], v16 offset:32
    ds_read_b64 v[36:37], v16 offset:64
    ds_read_b64 v[38:39], v16 offset:96
    ds_read_b64 v[40:41], v16 offset:128
    ds_read_b64 v[42:43], v16 offset:160
    ds_read_b64 v[44:45], v16 offset:192
    ds_read_b64 v[46:47], v16 offset:224
    ds_read_b64 v[48:49], v16 offset:256
    ds_read_b64 v[50:51], v16 offset:288
    ds_read_b64 v[52:53], v16 offset:320
    ds_read_b64 v[54:55], v16 offset:352
    ds_read_b64 v[56:57], v16 offset:384
    ds_read_b64 v[58:59], v16 offset:416
    ds_read_b64 v[60:61], v16 offset:448
    ds_read_b64 v[62:63], v16 offset:480
    ds_read_b64 v[64:65], v16 offset:512
    ds_read_b64 v[66:67], v16 offset:544
    ds_read_b64 v[68:69], v16 offset:576
    ds_read_b64 v[70:71], v16 offset:608
    ds_read_b64 v[72:73], v16 offset:640
    ds_read_b64 v[74:75], v16 offset:672
    ds_read_b64 v[76:77], v16 offset:704
    ds_read_b64 v[78:79], v16 offset:736
    ds_read_b64 v[80:81], v16 offset:768
    ds_read_b64 v[82:83], v16 offset:800
    ds_read_b64 v[84:85], v16 offset:832
    ds_read_b64 v[86:87], v16 offset:864
    s_waitcnt lgkmcnt(0)
    s_add_u32 s37, s39, 0x0
    buffer_store_dwordx4 v[32:35], v5, s[24:27], s37 offen
    s_add_u32 s37, s39, 0x400
    buffer_store_dwordx4 v[36:39], v5, s[24:27], s37 offen
    s_add_u32 s37, s39, 0x800
    buffer_store_dwordx4 v[40:43], v5, s[24:27], s37 offen
    s_add_u32 s37, s39, 0xc00
    buffer_store_dwordx4 v[44:47], v5, s[24:27], s37 offen
    s_add_u32 s37, s39, 0x1000
    buffer_store_dwordx4 v[48:51], v5, s[24:27], s37 offen
    s_add_u32 s37, s39, 0x1400
    buffer_store_dwordx4 v[52:55], v5, s[24:27], s37 offen
    s_add_u32 s37, s39, 0x1800
    buffer_store_dwordx4 v[56:59], v5, s[24:27], s37 offen
    s_add_u32 s37, s39, 0x1c00
    buffer_store_dwordx4 v[60:63], v5, s[24:27], s37 offen
    s_add_u32 s37, s39, 0x2000
    buffer_store_dwordx4 v[64:67], v5, s[24:27], s37 offen
    s_add_u32 s37, s39, 0x2400
    buffer_store_dwordx4 v[68:71], v5, s[24:27], s37 offen
    s_add_u32 s37, s39, 0x2800
    buffer_store_dwordx4 v[72:75], v5, s[24:27], s37 offen
    s_add_u32 s37, s39, 0x2c00
    buffer_store_dwordx4 v[76:79], v5, s[24:27], s37 offen
    s_add_u32 s37, s39, 0x3000
    buffer_store_dwordx4 v[80:83], v5, s[24:27], s37 offen
    s_add_u32 s37, s39, 0x3400
    buffer_store_dwordx4 v[84:87], v5, s[24:27], s37 offen
    v_dot2c_f32_bf16 v12, v32, v8
    v_dot2c_f32_bf16 v13, v32, v32
    v_dot2c_f32_bf16 v14, v33, v8
    v_dot2c_f32_bf16 v15, v33, v33
    v_dot2c_f32_bf16 v12, v34, v8
    v_dot2c_f32_bf16 v13, v34, v34
    v_dot2c_f32_bf16 v14, v35, v8
    v_dot2c_f32_bf16 v15, v35, v35
    v_dot2c_f32_bf16 v12, v36, v8
    v_dot2c_f32_bf16 v13, v36, v36
    v_dot2c_f32_bf16 v14, v37, v8
    v_dot2c_f32_bf16 v15, v37, v37
    v_dot2c_f32_bf16 v12, v38, v8
    v_dot2c_f32_bf16 v13, v38, v38
    v_dot2c_f32_bf16 v14, v39, v8
    v_dot2c_f32_bf16 v15, v39, v39
    v_dot2c_f32_bf16 v12, v40, v8
    v_dot2c_f32_bf16 v13, v40, v40
    v_dot2c_f32_bf16 v14, v41, v8
    v_dot2c_f32_bf16 v15, v41, v41
    v_dot2c_f32_bf16 v12, v42, v8
    v_dot2c_f32_bf16 v13, v42, v42
    v_dot2c_f32_bf16 v14, v43, v8
    v_dot2c_f32_bf16 v15, v43, v43
    v_dot2c_f32_bf16 v12, v44, v8
    v_dot2c_f32_bf16 v13, v44, v44
    v_dot2c_f32_bf16 v14, v45, v8
    v_dot2c_f32_bf16 v15, v45, v45
    v_dot2c_f32_bf16 v12, v46, v8
    v_dot2c_f32_bf16 v13, v46, v46
    v_dot2c_f32_bf16 v14, v47, v8
    v_dot2c_f32_bf16 v15, v47, v47
    v_dot2c_f32_bf16 v12, v48, v8
    v_dot2c_f32_bf16 v13, v48, v48
    v_dot2c_f32_bf16 v14, v49, v8
    v_dot2c_f32_bf16 v15, v49, v49
    v_dot2c_f32_bf16 v12, v50, v8
    v_dot2c_f32_bf16 v13, v50, v50
    v_dot2c_f32_bf16 v14, v51, v8
    v_dot2c_f32_bf16 v15, v51, v51
    v_dot2c_f32_bf16 v12, v52, v8
    v_dot2c_f32_bf16 v13, v52, v52
    v_dot2c_f32_bf16 v14, v53, v8
    v_dot2c_f32_bf16 v15, v53, v53
    v_dot2c_f32_bf16 v12, v54, v8
    v_dot2c_f32_bf16 v13, v54, v54
    v_dot2c_f32_bf16 v14, v55, v8
    v_dot2c_f32_bf16 v15, v55, v55
    v_dot2c_f32_bf16 v12, v56, v8
    v_dot2c_f32_bf16 v13, v56, v56
    v_dot2c_f32_bf16 v14, v57, v8
    v_dot2c_f32_bf16 v15, v57, v57
    v_dot2c_f32_bf16 v12, v58, v8
    v_dot2c_f32_bf16 v13, v58, v58
    v_dot2c_f32_bf16 v14, v59, v8
    v_dot2c_f32_bf16 v15, v59, v59
    v_dot2c_f32_bf16 v12, v60, v8
    v_dot2c_f32_bf16 v13, v60, v60
    v_dot2c_f32_bf16 v14, v61, v8
    v_dot2c_f32_bf16 v15, v61, v61
    v_dot2c_f32_bf16 v12, v62, v8
    v_dot2c_f32_bf16 v13, v62, v62
    v_dot2c_f32_bf16 v14, v63, v8
    v_dot2c_f32_bf16 v15, v63, v63
    v_dot2c_f32_bf16 v12, v64, v8
    v_dot2c_f32_bf16 v13, v64, v64
    v_dot2c_f32_bf16 v14, v65, v8
    v_dot2c_f32_bf16 v15, v65, v65
    v_dot2c_f32_bf16 v12, v66, v8
    v_dot2c_f32_bf16 v13, v66, v66
    v_dot2c_f32_bf16 v14, v67, v8
    v_dot2c_f32_bf16 v15, v67, v67
    v_dot2c_f32_bf16 v12, v68, v8
    v_dot2c_f32_bf16 v13, v68, v68
    v_dot2c_f32_bf16 v14, v69, v8
    v_dot2c_f32_bf16 v15, v69, v69
    v_dot2c_f32_bf16 v12, v70, v8
    v_dot2c_f32_bf16 v13, v70, v70
    v_dot2c_f32_bf16 v14, v71, v8
    v_dot2c_f32_bf16 v15, v71, v71
    v_dot2c_f32_bf16 v12, v72, v8
    v_dot2c_f32_bf16 v13, v72, v72
    v_dot2c_f32_bf16 v14, v73, v8
    v_dot2c_f32_bf16 v15, v73, v73
    v_dot2c_f32_bf16 v12, v74, v8
    v_dot2c_f32_bf16 v13, v74, v74
    v_dot2c_f32_bf16 v14, v75, v8
    v_dot2c_f32_bf16 v15, v75, v75
    v_dot2c_f32_bf16 v12, v76, v8
    v_dot2c_f32_bf16 v13, v76, v76
    v_dot2c_f32_bf16 v14, v77, v8
    v_dot2c_f32_bf16 v15, v77, v77
    v_dot2c_f32_bf16 v12, v78, v8
    v_dot2c_f32_bf16 v13, v78, v78
    v_dot2c_f32_bf16 v14, v79, v8
    v_dot2c_f32_bf16 v15, v79, v79
    v_dot2c_f32_bf16 v12, v80, v8
    v_dot2c_f32_bf16 v13, v80, v80
    v_dot2c_f32_bf16 v14, v81, v8
    v_dot2c_f32_bf16 v15, v81, v81
    v_dot2c_f32_bf16 v12, v82, v8
    v_dot2c_f32_bf16 v13, v82, v82
    v_dot2c_f32_bf16 v14, v83, v8
    v_dot2c_f32_bf16 v15, v83, v83
    v_dot2c_f32_bf16 v12, v84, v8
    v_dot2c_f32_bf16 v13, v84, v84
    v_dot2c_f32_bf16 v14, v85, v8
    v_dot2c_f32_bf16 v15, v85, v85
    v_dot2c_f32_bf16 v12, v86, v8
    v_dot2c_f32_bf16 v13, v86, v86
    v_dot2c_f32_bf16 v14, v87, v8
    v_dot2c_f32_bf16 v15, v87, v87
    s_nop 1
    v_add_f32 v12, v12, v14
    v_add_f32 v13, v13, v15
    v_mov_b32 v14, v12
    v_mov_b32 v15, v13
    s_nop 0
    v_permlane16_swap_b32 v12, v14
    v_permlane16_swap_b32 v13, v15
    v_add_f32 v12, v12, v14
    v_add_f32 v13, v13, v15
    v_mov_b32 v14, v12
    v_mov_b32 v15, v13
    s_nop 0
    v_permlane32_swap_b32 v12, v14
    v_permlane32_swap_b32 v13, v15
    v_add_f32 v12, v12, v14
    v_add_f32 v13, v13, v15
    v_mov_b32 v14, 0
    v_mov_b32 v15, 0
    v_cmp_eq_u32 vcc, 0, v4
    s_nop 1
    v_cndmask_b32 v12, 0, v12, vcc
    v_cndmask_b32 v13, 0, v13, vcc
    v_lshlrev_b32 v18, 7, v4
    v_lshlrev_b32 v17, 3, v3
    v_add_u32 v18, v18, v17
    v_mov_b32 v17, 0x40000000
    v_cmp_gt_u32 vcc, 2, v4
    s_nop 1
    v_cndmask_b32 v19, v17, v18, vcc
    s_mul_i32 s39, s32, 1792
    s_add_u32 s39, s39, 0xe70000
    buffer_store_dwordx2 v[12:13], v18, s[24:27], s39 offen
    buffer_store_dwordx2 v[14:15], v18, s[24:27], s39 offen offset:512
    buffer_store_dwordx2 v[14:15], v18, s[24:27], s39 offen offset:1024
    buffer_store_dwordx2 v[14:15], v19, s[24:27], s39 offen offset:1536
prep_done:
    s_nop 7
    s_nop 7
    s_endpgm
.globl megal0_kernel
.p2align 8
.type megal0_kernel,@function
megal0_kernel:
    s_mov_b32 s52, 0xaf0000
    s_mov_b32 s98, 0xe70000
    s_mov_b32 s53, 0x24d0000
    s_mov_b32 s54, 0x6b0000
    s_mov_b32 s55, 0x0
    s_mov_b32 s97, 0x0
    s_mov_b32 s80, 0xee0000
    s_mov_b32 s81, 0x10a0000
    s_mov_b32 s82, 0x10d8000
    s_mov_b32 s83, 0x17d8000
    s_branch k1_body
.p2align 6
k1_body:
    s_nop 7
    s_nop 7
    s_cmp_ge_u32 s2, 256
    s_cbranch_scc1 kb_done
    s_load_dwordx2 s[4:5], s[0:1], 64
    s_load_dwordx2 s[6:7], s[0:1], 80
    v_and_b32 v1, 63, v0
    v_lshrrev_b32 v2, 6, v0
    s_nop 0
    v_readfirstlane_b32 s3, v2
    v_and_b32 v3, 15, v1
    v_lshrrev_b32 v4, 4, v1
    v_lshlrev_b32 v5, 4, v1
    v_cmp_eq_u32 s[40:41], 3, v4
    v_lshlrev_b32 v6, 7, v4
    v_lshlrev_b32 v8, 3, v3
    v_add_u32 v6, v6, v8
    v_mov_b32 v8, 0x40000000
    v_cmp_gt_u32 vcc, 2, v4
    s_nop 1
    v_cndmask_b32 v7, v8, v6, vcc
    s_and_b32 s20, s2, 7
    s_lshr_b32 s21, s2, 3
    s_and_b32 s22, s20, 3
    s_lshl_b32 s22, s22, 2
    s_and_b32 s23, s21, 3
    s_add_u32 s22, s22, s23
    s_lshr_b32 s23, s20, 2
    s_lshl_b32 s23, s23, 3
    s_lshr_b32 s24, s21, 2
    s_add_u32 s23, s23, s24
    s_lshl_b32 s24, s22, 3
    s_add_u32 s24, s24, s3
    s_mul_i32 s25, s24, 14336
    s_add_u32 s25, s25, s52
    s_add_u32 s44, s25, 0
    s_add_u32 s45, s25, 4096
    s_add_u32 s46, s25, 8192
    s_add_u32 s47, s25, 12288
    s_mul_i32 s26, s23, 86016
    s_add_u32 s26, s26, 0x0
    s_lshl_b32 s27, s3, 10
    s_add_u32 s26, s26, s27
    s_mul_i32 s30, s24, 1792
    s_add_u32 s30, s30, s98
    s_mul_i32 s35, s23, 6144
    s_add_u32 s35, s35, 0x150000
    s_add_u32 s36, s35, 4096
    s_lshl_b32 s32, s23, 11
    s_add_u32 s32, s32, 0x168000
    s_waitcnt lgkmcnt(0)
    s_mov_b32 s8, s6
    s_and_b32 s9, s7, 0xffff
    s_mov_b32 s10, 0x24e0000
    s_mov_b32 s11, 0x20000
    s_mov_b32 s16, s4
    s_and_b32 s17, s5, 0xffff
    s_mov_b32 s18, 0x1c0000
    s_mov_b32 s19, 0x20000
    s_mov_b32 m0, s27
    s_nop 0
    buffer_load_dwordx4 v5, s[8:11], s26 offen lds
    s_add_u32 s26, s26, 8192
    s_add_u32 s27, s27, 8192
    s_mov_b32 m0, s27
    s_nop 0
    buffer_load_dwordx4 v5, s[8:11], s26 offen lds
    s_add_u32 s26, s26, 8192
    s_add_u32 s27, s27, 8192
    s_mov_b32 m0, s27
    s_nop 0
    buffer_load_dwordx4 v5, s[8:11], s26 offen lds
    s_add_u32 s26, s26, 8192
    s_add_u32 s27, s27, 8192
    s_mov_b32 m0, s27
    s_nop 0
    buffer_load_dwordx4 v5, s[8:11], s26 offen lds
    s_add_u32 s26, s26, 8192
    s_add_u32 s27, s27, 8192
    s_mov_b32 m0, s27
    s_nop 0
    buffer_load_dwordx4 v5, s[8:11], s26 offen lds
    s_add_u32 s26, s26, 8192
    s_add_u32 s27, s27, 8192
    s_mov_b32 m0, s27
    s_nop 0
    buffer_load_dwordx4 v5, s[8:11], s26 offen lds
    s_add_u32 s26, s26, 8192
    s_add_u32 s27, s27, 8192
    s_mov_b32 m0, s27
    s_nop 0
    buffer_load_dwordx4 v5, s[8:11], s26 offen lds
    s_add_u32 s26, s26, 8192
    s_add_u32 s27, s27, 8192
    s_mov_b32 m0, s27
    s_nop 0
    buffer_load_dwordx4 v5, s[8:11], s26 offen lds
    s_add_u32 s26, s26, 8192
    s_add_u32 s27, s27, 8192
    s_mov_b32 m0, s27
    s_nop 0
    buffer_load_dwordx4 v5, s[8:11], s26 offen lds
    s_add_u32 s26, s26, 8192
    s_add_u32 s27, s27, 8192
    s_mov_b32 m0, s27
    s_nop 0
    buffer_load_dwordx4 v5, s[8:11], s26 offen lds
    s_add_u32 s26, s26, 8192
    s_add_u32 s27, s27, 8192
    s_mov_b32 m0, s27
    s_nop 0
    buffer_load_dwordx4 v5, s[8:11], s26 offen lds
    buffer_load_dwordx4 v[112:115], v5, s[8:11], s35 offen offset:0
    buffer_load_dwordx4 v[116:119], v5, s[8:11], s35 offen offset:1024
    buffer_load_dwordx4 v[120:123], v5, s[8:11], s35 offen offset:2048
    buffer_load_dwordx4 v[124:127], v5, s[8:11], s35 offen offset:3072
    buffer_load_dwordx4 v[128:131], v5, s[8:11], s36 offen offset:0
    buffer_load_dwordx4 v[132:135], v5, s[8:11], s36 offen offset:1024
    buffer_load_dwordx4 v[136:139], v5, s[8:11], s32 offen offset:0
    buffer_load_dwordx4 v[140:143], v5, s[8:11], s32 offen offset:1024
    s_cmp_eq_u32 s97, 0
    s_cbranch_scc1 k1_nowait
    s_lshl_b32 s49, s22, 8
    s_add_u32 s49, s49, s97
    s_cmp_lg_u32 s3, 7
    s_cbranch_scc1 sync_skip_c
    v_mov_b32 v1, 0
    s_mov_b64 s[58:59], exec
    s_mov_b64 exec, 1
    s_mov_b32 s56, 0
sync_poll_c:
    buffer_load_dword v2, v1, s[8:11], s49 offen sc1
    s_waitcnt vmcnt(0)
    v_readfirstlane_b32 s57, v2
    s_nop 0
    s_cmp_ge_u32 s57, 14
    s_cbranch_scc1 sync_done_c
    s_sleep 1
    s_add_u32 s56, s56, 1
    s_cmp_lt_u32 s56, 0x8000
    s_cbranch_scc1 sync_poll_c
sync_done_c:
    s_mov_b64 exec, s[58:59]
    v_and_b32 v1, 63, v0
sync_skip_c:
    s_nop 4
    s_barrier
k1_nowait:
    buffer_load_dwordx4 v[200:203], v5, s[8:11], s44 offen offset:0 sc1
    buffer_load_dwordx4 v[204:207], v5, s[8:11], s44 offen offset:1024 sc1
    buffer_load_dwordx4 v[208:211], v5, s[8:11], s44 offen offset:2048 sc1
    buffer_load_dwordx4 v[212:215], v5, s[8:11], s44 offen offset:3072 sc1
    buffer_load_dwordx4 v[216:219], v5, s[8:11], s45 offen offset:0 sc1
    buffer_load_dwordx4 v[220:223], v5, s[8:11], s45 offen offset:1024 sc1
    buffer_load_dwordx4 v[224:227], v5, s[8:11], s45 offen offset:2048 sc1
    v_mov_b32 v150, 0x3fb8aa3b
    v_mov_b32 v144, 0
    v_mov_b32 v145, 0
    v_mov_b32 v148, 0
    v_mov_b32 v149, 0
    v_lshrrev_b32 v8, 2, v3
    v_cmp_eq_u32 vcc, v8, v4
    v_and_b32 v9, 3, v3
    v_and_b32 v10, 1, v9
    v_lshlrev_b32 v10, 4, v10
    v_mov_b32 v11, 0x3f80
    v_lshlrev_b32 v11, v10, v11
    v_cndmask_b32 v11, 0, v11, vcc
    v_cmp_gt_u32 vcc, 2, v9
    s_nop 1
    v_cndmask_b32 v146, 0, v11, vcc
    v_cndmask_b32 v147, v11, 0, vcc
    v_add_u32 v8, 43008, v5
    s_waitcnt vmcnt(6)
    s_barrier
    ds_read_b128 v[16:19], v5 offset:0
    ds_read_b128 v[20:23], v5 offset:1024
    ds_read_b128 v[24:27], v5 offset:2048
    ds_read_b128 v[28:31], v5 offset:3072
    ds_read_b128 v[32:35], v5 offset:4096
    ds_read_b128 v[36:39], v5 offset:5120
    ds_read_b128 v[40:43], v5 offset:6144
    ds_read_b128 v[44:47], v5 offset:7168
    ds_read_b128 v[48:51], v5 offset:8192
    ds_read_b128 v[52:55], v5 offset:9216
    ds_read_b128 v[56:59], v5 offset:10240
    ds_read_b128 v[60:63], v5 offset:11264
    s_waitcnt vmcnt(6) lgkmcnt(6)
    v_mfma_f32_16x16x32_bf16 v[72:75], v[24:27], v[200:203], 0
    v_mfma_f32_16x16x32_bf16 v[76:79], v[28:31], v[200:203], 0
    buffer_load_dwordx4 v[228:231], v5, s[8:11], s45 offen offset:3072 sc1
    v_mfma_f32_16x16x32_bf16 v[80:83], v[32:35], v[200:203], 0
    v_mfma_f32_16x16x32_bf16 v[84:87], v[36:39], v[200:203], 0
    buffer_load_dwordx4 v[232:235], v5, s[8:11], s46 offen offset:0 sc1
    v_mfma_f32_16x16x32_bf16 v[64:67], v[16:19], v[200:203], 0
    v_mfma_f32_16x16x32_bf16 v[68:71], v[20:23], v[200:203], 0
    ds_read_b128 v[16:19], v5 offset:12288
    ds_read_b128 v[20:23], v5 offset:13312
    ds_read_b128 v[24:27], v5 offset:14336
    ds_read_b128 v[28:31], v5 offset:15360
    ds_read_b128 v[32:35], v5 offset:16384
    ds_read_b128 v[36:39], v5 offset:17408
    s_waitcnt vmcnt(7) lgkmcnt(6)
    v_mfma_f32_16x16x32_bf16 v[72:75], v[48:51], v[204:207], v[72:75]
    v_mfma_f32_16x16x32_bf16 v[76:79], v[52:55], v[204:207], v[76:79]
    buffer_load_dwordx4 v[236:239], v5, s[8:11], s46 offen offset:1024 sc1
    v_mfma_f32_16x16x32_bf16 v[80:83], v[56:59], v[204:207], v[80:83]
    v_mfma_f32_16x16x32_bf16 v[84:87], v[60:63], v[204:207], v[84:87]
    buffer_load_dwordx4 v[240:243], v5, s[8:11], s46 offen offset:2048 sc1
    v_mfma_f32_16x16x32_bf16 v[64:67], v[40:43], v[204:207], v[64:67]
    v_mfma_f32_16x16x32_bf16 v[68:71], v[44:47], v[204:207], v[68:71]
    ds_read_b128 v[40:43], v5 offset:18432
    ds_read_b128 v[44:47], v5 offset:19456
    ds_read_b128 v[48:51], v5 offset:20480
    ds_read_b128 v[52:55], v5 offset:21504
    ds_read_b128 v[56:59], v5 offset:22528
    ds_read_b128 v[60:63], v5 offset:23552
    s_waitcnt vmcnt(8) lgkmcnt(6)
    v_mfma_f32_16x16x32_bf16 v[72:75], v[24:27], v[208:211], v[72:75]
    v_mfma_f32_16x16x32_bf16 v[76:79], v[28:31], v[208:211], v[76:79]
    buffer_load_dwordx4 v[244:247], v5, s[8:11], s46 offen offset:3072 sc1
    v_mfma_f32_16x16x32_bf16 v[80:83], v[32:35], v[208:211], v[80:83]
    v_mfma_f32_16x16x32_bf16 v[84:87], v[36:39], v[208:211], v[84:87]
    buffer_load_dwordx4 v[248:251], v5, s[8:11], s47 offen offset:0 sc1
    v_mfma_f32_16x16x32_bf16 v[64:67], v[16:19], v[208:211], v[64:67]
    v_mfma_f32_16x16x32_bf16 v[68:71], v[20:23], v[208:211], v[68:71]
    ds_read_b128 v[16:19], v5 offset:24576
    ds_read_b128 v[20:23], v5 offset:25600
    ds_read_b128 v[24:27], v5 offset:26624
    ds_read_b128 v[28:31], v5 offset:27648
    ds_read_b128 v[32:35], v5 offset:28672
    ds_read_b128 v[36:39], v5 offset:29696
    s_waitcnt vmcnt(9) lgkmcnt(6)
    v_mfma_f32_16x16x32_bf16 v[72:75], v[48:51], v[212:215], v[72:75]
    v_mfma_f32_16x16x32_bf16 v[76:79], v[52:55], v[212:215], v[76:79]
    buffer_load_dwordx4 v[252:255], v5, s[8:11], s47 offen offset:1024 sc1
    v_mfma_f32_16x16x32_bf16 v[80:83], v[56:59], v[212:215], v[80:83]
    v_mfma_f32_16x16x32_bf16 v[84:87], v[60:63], v[212:215], v[84:87]
    v_mfma_f32_16x16x32_bf16 v[64:67], v[40:43], v[212:215], v[64:67]
    v_mfma_f32_16x16x32_bf16 v[68:71], v[44:47], v[212:215], v[68:71]
    ds_read_b128 v[40:43], v5 offset:30720
    ds_read_b128 v[44:47], v5 offset:31744
    ds_read_b128 v[48:51], v5 offset:32768
    ds_read_b128 v[52:55], v5 offset:33792
    ds_read_b128 v[56:59], v5 offset:34816
    ds_read_b128 v[60:63], v5 offset:35840
    s_waitcnt vmcnt(9) lgkmcnt(6)
    v_mfma_f32_16x16x32_bf16 v[72:75], v[24:27], v[216:219], v[72:75]
    v_mfma_f32_16x16x32_bf16 v[76:79], v[28:31], v[216:219], v[76:79]
    buffer_load_dwordx2 v[156:157], v6, s[8:11], s30 offen offset:0 sc1
    buffer_load_dwordx2 v[158:159], v6, s[8:11], s30 offen offset:512 sc1
    buffer_load_dwordx2 v[160:161], v6, s[8:11], s30 offen offset:1024 sc1
    buffer_load_dwordx2 v[162:163], v7, s[8:11], s30 offen offset:1536 sc1
    v_mfma_f32_16x16x32_bf16 v[80:83], v[32:35], v[216:219], v[80:83]
    v_mfma_f32_16x16x32_bf16 v[84:87], v[36:39], v[216:219], v[84:87]
    v_mfma_f32_16x16x32_bf16 v[64:67], v[16:19], v[216:219], v[64:67]
    v_mfma_f32_16x16x32_bf16 v[68:71], v[20:23], v[216:219], v[68:71]
    ds_read_b128 v[16:19], v5 offset:36864
    ds_read_b128 v[20:23], v5 offset:37888
    ds_read_b128 v[24:27], v5 offset:38912
    ds_read_b128 v[28:31], v5 offset:39936
    ds_read_b128 v[32:35], v5 offset:40960
    ds_read_b128 v[36:39], v5 offset:41984
    s_waitcnt vmcnt(12) lgkmcnt(6)
    v_mfma_f32_16x16x32_bf16 v[72:75], v[48:51], v[220:223], v[72:75]
    v_mfma_f32_16x16x32_bf16 v[76:79], v[52:55], v[220:223], v[76:79]
    v_mfma_f32_16x16x32_bf16 v[80:83], v[56:59], v[220:223], v[80:83]
    v_mfma_f32_16x16x32_bf16 v[84:87], v[60:63], v[220:223], v[84:87]
    v_mfma_f32_16x16x32_bf16 v[64:67], v[40:43], v[220:223], v[64:67]
    v_mfma_f32_16x16x32_bf16 v[68:71], v[44:47], v[220:223], v[68:71]
    ds_read_b128 v[40:43], v8 offset:0
    ds_read_b128 v[44:47], v8 offset:1024
    ds_read_b128 v[48:51], v8 offset:2048
    ds_read_b128 v[52:55], v8 offset:3072
    ds_read_b128 v[56:59], v8 offset:4096
    ds_read_b128 v[60:63], v8 offset:5120
    s_waitcnt vmcnt(11) lgkmcnt(6)
    v_mfma_f32_16x16x32_bf16 v[72:75], v[24:27], v[224:227], v[72:75]
    v_mfma_f32_16x16x32_bf16 v[76:79], v[28:31], v[224:227], v[76:79]
    v_mfma_f32_16x16x32_bf16 v[80:83], v[32:35], v[224:227], v[80:83]
    v_mfma_f32_16x16x32_bf16 v[84:87], v[36:39], v[224:227], v[84:87]
    v_mfma_f32_16x16x32_bf16 v[64:67], v[16:19], v[224:227], v[64:67]
    v_mfma_f32_16x16x32_bf16 v[68:71], v[20:23], v[224:227], v[68:71]
    ds_read_b128 v[16:19], v8 offset:6144
    ds_read_b128 v[20:23], v8 offset:7168
    ds_read_b128 v[24:27], v8 offset:8192
    ds_read_b128 v[28:31], v8 offset:9216
    ds_read_b128 v[32:35], v8 offset:10240
    ds_read_b128 v[36:39], v8 offset:11264
    s_waitcnt vmcnt(10) lgkmcnt(6)
    v_mfma_f32_16x16x32_bf16 v[72:75], v[48:51], v[228:231], v[72:75]
    v_mfma_f32_16x16x32_bf16 v[76:79], v[52:55], v[228:231], v[76:79]
    v_mfma_f32_16x16x32_bf16 v[80:83], v[56:59], v[228:231], v[80:83]
    v_mfma_f32_16x16x32_bf16 v[84:87], v[60:63], v[228:231], v[84:87]
    v_mfma_f32_16x16x32_bf16 v[64:67], v[40:43], v[228:231], v[64:67]
    v_mfma_f32_16x16x32_bf16 v[68:71], v[44:47], v[228:231], v[68:71]
    ds_read_b128 v[40:43], v8 offset:12288
    ds_read_b128 v[44:47], v8 offset:13312
    ds_read_b128 v[48:51], v8 offset:14336
    ds_read_b128 v[52:55], v8 offset:15360
    ds_read_b128 v[56:59], v8 offset:16384
    ds_read_b128 v[60:63], v8 offset:17408
    s_waitcnt vmcnt(9) lgkmcnt(6)
    v_mfma_f32_16x16x32_bf16 v[72:75], v[24:27], v[232:235], v[72:75]
    v_mfma_f32_16x16x32_bf16 v[76:79], v[28:31], v[232:235], v[76:79]
    v_mfma_f32_16x16x32_bf16 v[80:83], v[32:35], v[232:235], v[80:83]
    v_mfma_f32_16x16x32_bf16 v[84:87], v[36:39], v[232:235], v[84:87]
    v_mfma_f32_16x16x32_bf16 v[64:67], v[16:19], v[232:235], v[64:67]
    v_mfma_f32_16x16x32_bf16 v[68:71], v[20:23], v[232:235], v[68:71]
    ds_read_b128 v[16:19], v8 offset:18432
    ds_read_b128 v[20:23], v8 offset:19456
    ds_read_b128 v[24:27], v8 offset:20480
    ds_read_b128 v[28:31], v8 offset:21504
    ds_read_b128 v[32:35], v8 offset:22528
    ds_read_b128 v[36:39], v8 offset:23552
    s_waitcnt vmcnt(8) lgkmcnt(6)
    v_mfma_f32_16x16x32_bf16 v[72:75], v[48:51], v[236:239], v[72:75]
    v_mfma_f32_16x16x32_bf16 v[76:79], v[52:55], v[236:239], v[76:79]
    v_mfma_f32_16x16x32_bf16 v[80:83], v[56:59], v[236:239], v[80:83]
    v_mfma_f32_16x16x32_bf16 v[84:87], v[60:63], v[236:239], v[84:87]
    v_mfma_f32_16x16x32_bf16 v[64:67], v[40:43], v[236:239], v[64:67]
    v_mfma_f32_16x16x32_bf16 v[68:71], v[44:47], v[236:239], v[68:71]
    ds_read_b128 v[40:43], v8 offset:24576
    ds_read_b128 v[44:47], v8 offset:25600
    ds_read_b128 v[48:51], v8 offset:26624
    ds_read_b128 v[52:55], v8 offset:27648
    ds_read_b128 v[56:59], v8 offset:28672
    ds_read_b128 v[60:63], v8 offset:29696
    s_waitcnt vmcnt(7) lgkmcnt(6)
    v_mfma_f32_16x16x32_bf16 v[72:75], v[24:27], v[240:243], v[72:75]
    v_mfma_f32_16x16x32_bf16 v[76:79], v[28:31], v[240:243], v[76:79]
    v_mfma_f32_16x16x32_bf16 v[80:83], v[32:35], v[240:243], v[80:83]
    v_mfma_f32_16x16x32_bf16 v[84:87], v[36:39], v[240:243], v[84:87]
    v_mfma_f32_16x16x32_bf16 v[64:67], v[16:19], v[240:243], v[64:67]
    v_mfma_f32_16x16x32_bf16 v[68:71], v[20:23], v[240:243], v[68:71]
    ds_read_b128 v[16:19], v8 offset:30720
    ds_read_b128 v[20:23], v8 offset:31744
    ds_read_b128 v[24:27], v8 offset:32768
    ds_read_b128 v[28:31], v8 offset:33792
    ds_read_b128 v[32:35], v8 offset:34816
    ds_read_b128 v[36:39], v8 offset:35840
    s_waitcnt vmcnt(6) lgkmcnt(6)
    v_mfma_f32_16x16x32_bf16 v[72:75], v[48:51], v[244:247], v[72:75]
    v_mfma_f32_16x16x32_bf16 v[76:79], v[52:55], v[244:247], v[76:79]
    v_mfma_f32_16x16x32_bf16 v[80:83], v[56:59], v[244:247], v[80:83]
    v_mfma_f32_16x16x32_bf16 v[84:87], v[60:63], v[244:247], v[84:87]
    v_mfma_f32_16x16x32_bf16 v[64:67], v[40:43], v[244:247], v[64:67]
    v_mfma_f32_16x16x32_bf16 v[68:71], v[44:47], v[244:247], v[68:71]
    ds_read_b128 v[40:43], v8 offset:36864
    ds_read_b128 v[44:47], v8 offset:37888
    ds_read_b128 v[48:51], v8 offset:38912
    ds_read_b128 v[52:55], v8 offset:39936
    ds_read_b128 v[56:59], v8 offset:40960
    ds_read_b128 v[60:63], v8 offset:41984
    s_waitcnt vmcnt(5) lgkmcnt(6)
    v_mfma_f32_16x16x32_bf16 v[72:75], v[24:27], v[248:251], v[72:75]
    v_mfma_f32_16x16x32_bf16 v[76:79], v[28:31], v[248:251], v[76:79]
    v_mfma_f32_16x16x32_bf16 v[80:83], v[32:35], v[248:251], v[80:83]
    v_mfma_f32_16x16x32_bf16 v[84:87], v[36:39], v[248:251], v[84:87]
    v_mfma_f32_16x16x32_bf16 v[64:67], v[16:19], v[248:251], v[64:67]
    v_mfma_f32_16x16x32_bf16 v[68:71], v[20:23], v[248:251], v[68:71]
    s_waitcnt vmcnt(4) lgkmcnt(0)
    v_mfma_f32_16x16x32_bf16 v[72:75], v[48:51], v[252:255], v[72:75]
    v_mfma_f32_16x16x32_bf16 v[76:79], v[52:55], v[252:255], v[76:79]
    v_mfma_f32_16x16x32_bf16 v[80:83], v[56:59], v[252:255], v[80:83]
    v_mfma_f32_16x16x32_bf16 v[84:87], v[60:63], v[252:255], v[84:87]
    v_mfma_f32_16x16x32_bf16 v[64:67], v[40:43], v[252:255], v[64:67]
    v_mfma_f32_16x16x32_bf16 v[68:71], v[44:47], v[252:255], v[68:71]
    s_waitcnt vmcnt(0)
    v_add_f32 v156, v156, v158
    v_add_f32 v157, v157, v159
    v_add_f32 v160, v160, v162
    v_add_f32 v161, v161, v163
    v_add_f32 v156, v156, v160
    v_add_f32 v157, v157, v161
    v_mov_b32 v9, v156
    v_mov_b32 v10, v157
    s_nop 0
    v_permlane16_swap_b32 v156, v9
    v_permlane16_swap_b32 v157, v10
    v_add_f32 v156, v156, v9
    v_add_f32 v157, v157, v10
    v_mov_b32 v9, v156
    v_mov_b32 v10, v157
    s_nop 0
    v_permlane32_swap_b32 v156, v9
    v_permlane32_swap_b32 v157, v10
    v_add_f32 v156, v156, v9
    v_add_f32 v157, v157, v10
    v_mul_f32 v156, 0x3b124925, v156
    v_mul_f32 v157, 0x3b124925, v157
    v_fma_f32 v157, -v156, v156, v157
    v_max_f32 v157, 0, v157
    v_cvt_pk_bf16_f32 v9, v156, v157
    v_lshlrev_b32 v152, 16, v9
    v_and_b32 v10, 0xffff0000, v9
    v_add_f32 v10, 0x3727c5ac, v10
    v_cvt_pk_bf16_f32 v9, v10, v10
    v_lshlrev_b32 v10, 16, v9
    v_sqrt_f32 v10, v10
    s_nop 0
    v_cvt_pk_bf16_f32 v9, v10, v10
    v_lshlrev_b32 v10, 16, v9
    v_rcp_f32 v154, v10
    v_mov_b32 v9, 0x3f80
    v_fma_f32 v72, -v152, v120, v72
    v_fma_f32 v73, -v152, v121, v73
    v_fma_f32 v74, -v152, v122, v74
    v_fma_f32 v75, -v152, v123, v75
    v_mul_f32 v72, v72, v154
    v_mul_f32 v73, v73, v154
    v_mul_f32 v74, v74, v154
    v_mul_f32 v75, v75, v154
    v_cvt_pk_bf16_f32 v16, v72, v73
    v_cvt_pk_bf16_f32 v17, v74, v75
    v_fma_f32 v76, -v152, v124, v76
    v_fma_f32 v77, -v152, v125, v77
    v_fma_f32 v78, -v152, v126, v78
    v_fma_f32 v79, -v152, v127, v79
    v_mul_f32 v76, v76, v154
    v_mul_f32 v77, v77, v154
    v_mul_f32 v78, v78, v154
    v_mul_f32 v79, v79, v154
    v_cvt_pk_bf16_f32 v18, v76, v77
    v_cvt_pk_bf16_f32 v19, v78, v79
    s_nop 1
    v_mfma_f32_16x16x32_bf16 v[164:167], v[136:139], v[16:19], 0
    v_mfma_f32_16x16x32_bf16 v[168:171], v[140:143], v[16:19], 0
    v_fma_f32 v80, -v152, v128, v80
    v_fma_f32 v81, -v152, v129, v81
    v_fma_f32 v82, -v152, v130, v82
    v_fma_f32 v83, -v152, v131, v83
    v_mul_f32 v80, v80, v154
    v_mul_f32 v81, v81, v154
    v_mul_f32 v82, v82, v154
    v_mul_f32 v83, v83, v154
    v_cvt_pk_bf16_f32 v20, v80, v81
    v_cvt_pk_bf16_f32 v21, v82, v83
    v_fma_f32 v84, -v152, v132, v84
    v_fma_f32 v85, -v152, v133, v85
    v_fma_f32 v86, -v152, v134, v86
    v_fma_f32 v87, -v152, v135, v87
    v_mul_f32 v84, v84, v154
    v_mul_f32 v85, v85, v154
    v_mul_f32 v86, v86, v154
    v_mul_f32 v87, v87, v154
    v_cvt_pk_bf16_f32 v22, v84, v85
    v_cvt_pk_bf16_f32 v23, v86, v87
    v_cndmask_b32 v22, v22, v9, s[40:41]
    v_fma_f32 v64, -v152, v112, v64
    v_fma_f32 v65, -v152, v113, v65
    v_fma_f32 v66, -v152, v114, v66
    v_fma_f32 v67, -v152, v115, v67
    v_mul_f32 v64, v64, v154
    v_mul_f32 v65, v65, v154
    v_mul_f32 v66, v66, v154
    v_mul_f32 v67, v67, v154
    v_cvt_pk_bf16_f32 v24, v64, v65
    v_cvt_pk_bf16_f32 v25, v66, v67
    v_fma_f32 v68, -v152, v116, v68
    v_fma_f32 v69, -v152, v117, v69
    v_fma_f32 v70, -v152, v118, v70
    v_fma_f32 v71, -v152, v119, v71
    v_mul_f32 v68, v68, v154
    v_mul_f32 v69, v69, v154
    v_mul_f32 v70, v70, v154
    v_mul_f32 v71, v71, v154
    v_cvt_pk_bf16_f32 v26, v68, v69
    v_cvt_pk_bf16_f32 v27, v70, v71
    s_nop 1
    v_mfma_f32_16x16x32_bf16 v[172:175], v[136:139], v[24:27], 0
    v_mfma_f32_16x16x32_bf16 v[176:179], v[140:143], v[24:27], 0
    v_mov_b32 v38, 0
    v_mov_b32 v39, 0
    v_mov_b32 v42, 0
    v_mov_b32 v43, 0
    v_mov_b32 v46, 0
    v_mov_b32 v47, 0
    v_mov_b32 v50, 0
    v_mov_b32 v51, 0
    v_mov_b32 v54, 0
    v_mov_b32 v55, 0
    v_mov_b32 v58, 0
    v_mov_b32 v59, 0
    v_max3_f32 v198, v168, v169, v170
    v_min3_f32 v199, v168, v169, v170
    v_max_f32 v198, v198, v171
    v_min_f32 v199, v199, v171
    v_cndmask_b32 v198, v198, v164, s[40:41]
    v_cndmask_b32 v199, v199, v164, s[40:41]
    v_max3_f32 v196, v164, v165, v166
    v_min3_f32 v197, v164, v165, v166
    v_max3_f32 v196, v196, v167, v198
    v_min3_f32 v197, v197, v167, v199
    v_mov_b32 v198, v196
    v_mov_b32 v199, v197
    s_nop 0
    v_permlane16_swap_b32 v196, v198
    v_permlane16_swap_b32 v197, v199
    v_max_f32 v196, v196, v198
    v_min_f32 v197, v197, v199
    v_mov_b32 v198, v196
    v_mov_b32 v199, v197
    s_nop 0
    v_permlane32_swap_b32 v196, v198
    v_permlane32_swap_b32 v197, v199
    v_max_f32 v196, v196, v198
    v_min_f32 v197, v197, v199
    v_mul_f32 v196, v196, v150
    v_mul_f32 v197, v197, v150
    v_fma_f32 v180, v164, v150, -v196
    v_fma_f32 v188, -v164, v150, v197
    v_fma_f32 v181, v165, v150, -v196
    v_fma_f32 v189, -v165, v150, v197
    v_fma_f32 v182, v166, v150, -v196
    v_fma_f32 v190, -v166, v150, v197
    v_fma_f32 v183, v167, v150, -v196
    v_fma_f32 v191, -v167, v150, v197
    v_fma_f32 v184, v168, v150, -v196
    v_fma_f32 v192, -v168, v150, v197
    v_fma_f32 v185, v169, v150, -v196
    v_fma_f32 v193, -v169, v150, v197
    v_fma_f32 v186, v170, v150, -v196
    v_fma_f32 v194, -v170, v150, v197
    v_fma_f32 v187, v171, v150, -v196
    v_fma_f32 v195, -v171, v150, v197
    v_exp_f32 v180, v180
    v_exp_f32 v188, v188
    v_exp_f32 v181, v181
    v_exp_f32 v189, v189
    v_exp_f32 v182, v182
    v_exp_f32 v190, v190
    v_exp_f32 v183, v183
    v_exp_f32 v191, v191
    v_exp_f32 v184, v184
    v_exp_f32 v192, v192
    v_exp_f32 v185, v185
    v_exp_f32 v193, v193
    v_exp_f32 v186, v186
    v_exp_f32 v194, v194
    v_exp_f32 v187, v187
    v_exp_f32 v195, v195
    v_cndmask_b32 v184, v184, 0, s[40:41]
    v_cndmask_b32 v192, v192, 0, s[40:41]
    v_cndmask_b32 v185, v185, 0, s[40:41]
    v_cndmask_b32 v193, v193, 0, s[40:41]
    v_cndmask_b32 v186, v186, 0, s[40:41]
    v_cndmask_b32 v194, v194, 0, s[40:41]
    v_cndmask_b32 v187, v187, 0, s[40:41]
    v_cndmask_b32 v195, v195, 0, s[40:41]
    v_add_f32 v196, v180, v181
    v_add_f32 v197, v188, v189
    v_add_f32 v196, v196, v182
    v_add_f32 v197, v197, v190
    v_add_f32 v196, v196, v183
    v_add_f32 v197, v197, v191
    v_add_f32 v196, v196, v184
    v_add_f32 v197, v197, v192
    v_add_f32 v196, v196, v185
    v_add_f32 v197, v197, v193
    v_add_f32 v196, v196, v186
    v_add_f32 v197, v197, v194
    v_add_f32 v196, v196, v187
    v_add_f32 v197, v197, v195
    v_mov_b32 v198, v196
    v_mov_b32 v199, v197
    s_nop 0
    v_permlane16_swap_b32 v196, v198
    v_permlane16_swap_b32 v197, v199
    v_add_f32 v196, v196, v198
    v_add_f32 v197, v197, v199
    v_mov_b32 v198, v196
    v_mov_b32 v199, v197
    s_nop 0
    v_permlane32_swap_b32 v196, v198
    v_permlane32_swap_b32 v197, v199
    v_add_f32 v196, v196, v198
    v_add_f32 v197, v197, v199
    v_rcp_f32 v196, v196
    v_rcp_f32 v197, v197
    v_mul_f32 v180, v180, v196
    v_mul_f32 v188, v188, v197
    v_mul_f32 v181, v181, v196
    v_mul_f32 v189, v189, v197
    v_mul_f32 v182, v182, v196
    v_mul_f32 v190, v190, v197
    v_mul_f32 v183, v183, v196
    v_mul_f32 v191, v191, v197
    v_mul_f32 v184, v184, v196
    v_mul_f32 v192, v192, v197
    v_mul_f32 v185, v185, v196
    v_mul_f32 v193, v193, v197
    v_mul_f32 v186, v186, v196
    v_mul_f32 v194, v194, v197
    v_mul_f32 v187, v187, v196
    v_mul_f32 v195, v195, v197
    v_cvt_pk_bf16_f32 v28, v180, v181
    v_cvt_pk_bf16_f32 v32, v188, v189
    v_cvt_pk_bf16_f32 v29, v182, v183
    v_cvt_pk_bf16_f32 v33, v190, v191
    v_cvt_pk_bf16_f32 v30, v184, v185
    v_cvt_pk_bf16_f32 v34, v192, v193
    v_cvt_pk_bf16_f32 v31, v186, v187
    v_cvt_pk_bf16_f32 v35, v194, v195
    s_nop 0
    v_mfma_f32_16x16x32_bf16 v[64:67], v[28:31], v[146:149], 0
    v_mfma_f32_16x16x32_bf16 v[68:71], v[28:31], v[144:147], 0
    v_mfma_f32_16x16x32_bf16 v[72:75], v[32:35], v[146:149], 0
    v_mfma_f32_16x16x32_bf16 v[76:79], v[32:35], v[144:147], 0
    v_mfma_f32_16x16x32_bf16 v[80:83], v[20:23], v[146:149], 0
    v_mfma_f32_16x16x32_bf16 v[84:87], v[20:23], v[144:147], 0
    s_nop 2
    v_cvt_pk_bf16_f32 v36, v64, v65
    v_cvt_pk_bf16_f32 v37, v66, v67
    v_cvt_pk_bf16_f32 v40, v68, v69
    v_cvt_pk_bf16_f32 v41, v70, v71
    v_cvt_pk_bf16_f32 v44, v72, v73
    v_cvt_pk_bf16_f32 v45, v74, v75
    v_cvt_pk_bf16_f32 v48, v76, v77
    v_cvt_pk_bf16_f32 v49, v78, v79
    v_cvt_pk_bf16_f32 v52, v80, v81
    v_cvt_pk_bf16_f32 v53, v82, v83
    v_cvt_pk_bf16_f32 v56, v84, v85
    v_cvt_pk_bf16_f32 v57, v86, v87
    v_mfma_f32_16x16x32_bf16 v[64:67], v[36:39], v[52:55], 0
    s_nop 0
    v_mfma_f32_16x16x32_bf16 v[68:71], v[36:39], v[56:59], 0
    v_mfma_f32_16x16x32_bf16 v[72:75], v[40:43], v[52:55], 0
    v_mfma_f32_16x16x32_bf16 v[76:79], v[40:43], v[56:59], 0
    v_mfma_f32_16x16x32_bf16 v[80:83], v[44:47], v[52:55], 0
    v_mfma_f32_16x16x32_bf16 v[84:87], v[44:47], v[56:59], 0
    v_mfma_f32_16x16x32_bf16 v[88:91], v[48:51], v[52:55], 0
    v_mfma_f32_16x16x32_bf16 v[92:95], v[48:51], v[56:59], 0
    s_lshl_b32 s33, s3, 13
    s_add_u32 s33, s33, 86016
    v_add_u32 v9, s33, v5
    ds_write_b128 v9, v[64:67] offset:0
    ds_write_b128 v9, v[68:71] offset:1024
    ds_write_b128 v9, v[72:75] offset:2048
    ds_write_b128 v9, v[76:79] offset:3072
    ds_write_b128 v9, v[80:83] offset:4096
    ds_write_b128 v9, v[84:87] offset:5120
    ds_write_b128 v9, v[88:91] offset:6144
    ds_write_b128 v9, v[92:95] offset:7168
    s_waitcnt lgkmcnt(0)
    s_barrier
    s_lshl_b32 s33, s3, 10
    s_add_u32 s33, s33, 86016
    v_lshlrev_b32 v9, 2, v1
    v_add_u32 v10, s33, v9
    ds_read_b32 v64, v10 offset:0
    ds_read_b32 v65, v10 offset:256
    ds_read_b32 v66, v10 offset:512
    ds_read_b32 v67, v10 offset:768
    ds_read_b32 v68, v10 offset:8192
    ds_read_b32 v69, v10 offset:8448
    ds_read_b32 v70, v10 offset:8704
    ds_read_b32 v71, v10 offset:8960
    ds_read_b32 v72, v10 offset:16384
    ds_read_b32 v73, v10 offset:16640
    ds_read_b32 v74, v10 offset:16896
    ds_read_b32 v75, v10 offset:17152
    ds_read_b32 v76, v10 offset:24576
    ds_read_b32 v77, v10 offset:24832
    ds_read_b32 v78, v10 offset:25088
    ds_read_b32 v79, v10 offset:25344
    ds_read_b32 v80, v10 offset:32768
    ds_read_b32 v81, v10 offset:33024
    ds_read_b32 v82, v10 offset:33280
    ds_read_b32 v83, v10 offset:33536
    ds_read_b32 v84, v10 offset:40960
    ds_read_b32 v85, v10 offset:41216
    ds_read_b32 v86, v10 offset:41472
    ds_read_b32 v87, v10 offset:41728
    ds_read_b32 v88, v10 offset:49152
    ds_read_b32 v89, v10 offset:49408
    ds_read_b32 v90, v10 offset:49664
    ds_read_b32 v91, v10 offset:49920
    ds_read_b32 v92, v10 offset:57344
    ds_read_b32 v93, v10 offset:57600
    ds_read_b32 v94, v10 offset:57856
    ds_read_b32 v95, v10 offset:58112
    s_lshl_b32 s33, s23, 13
    s_add_u32 s33, s33, s54
    s_lshl_b32 s34, s3, 10
    s_add_u32 s33, s33, s34
    s_waitcnt lgkmcnt(0)
    v_add_f32 v64, v64, v80
    v_add_f32 v65, v65, v81
    v_add_f32 v66, v66, v82
    v_add_f32 v67, v67, v83
    v_add_f32 v68, v68, v84
    v_add_f32 v69, v69, v85
    v_add_f32 v70, v70, v86
    v_add_f32 v71, v71, v87
    v_add_f32 v72, v72, v88
    v_add_f32 v73, v73, v89
    v_add_f32 v74, v74, v90
    v_add_f32 v75, v75, v91
    v_add_f32 v76, v76, v92
    v_add_f32 v77, v77, v93
    v_add_f32 v78, v78, v94
    v_add_f32 v79, v79, v95
    v_add_f32 v64, v64, v72
    v_add_f32 v65, v65, v73
    v_add_f32 v66, v66, v74
    v_add_f32 v67, v67, v75
    v_add_f32 v68, v68, v76
    v_add_f32 v69, v69, v77
    v_add_f32 v70, v70, v78
    v_add_f32 v71, v71, v79
    v_add_f32 v64, v64, v68
    v_add_f32 v65, v65, v69
    v_add_f32 v66, v66, v70
    v_add_f32 v67, v67, v71
    buffer_atomic_add_f32 v64, v9, s[8:11], s33 offen offset:0
    buffer_atomic_add_f32 v65, v9, s[8:11], s33 offen offset:256
    buffer_atomic_add_f32 v66, v9, s[8:11], s33 offen offset:512
    buffer_atomic_add_f32 v67, v9, s[8:11], s33 offen offset:768
    v_max3_f32 v198, v176, v177, v178
    v_min3_f32 v199, v176, v177, v178
    v_max_f32 v198, v198, v179
    v_min_f32 v199, v199, v179
    v_cndmask_b32 v198, v198, v172, s[40:41]
    v_cndmask_b32 v199, v199, v172, s[40:41]
    v_max3_f32 v196, v172, v173, v174
    v_min3_f32 v197, v172, v173, v174
    v_max3_f32 v196, v196, v175, v198
    v_min3_f32 v197, v197, v175, v199
    v_mov_b32 v198, v196
    v_mov_b32 v199, v197
    s_nop 0
    v_permlane16_swap_b32 v196, v198
    v_permlane16_swap_b32 v197, v199
    v_max_f32 v196, v196, v198
    v_min_f32 v197, v197, v199
    v_mov_b32 v198, v196
    v_mov_b32 v199, v197
    s_nop 0
    v_permlane32_swap_b32 v196, v198
    v_permlane32_swap_b32 v197, v199
    v_max_f32 v196, v196, v198
    v_min_f32 v197, v197, v199
    v_mul_f32 v196, v196, v150
    v_mul_f32 v197, v197, v150
    v_fma_f32 v180, v172, v150, -v196
    v_fma_f32 v188, -v172, v150, v197
    v_fma_f32 v181, v173, v150, -v196
    v_fma_f32 v189, -v173, v150, v197
    v_fma_f32 v182, v174, v150, -v196
    v_fma_f32 v190, -v174, v150, v197
    v_fma_f32 v183, v175, v150, -v196
    v_fma_f32 v191, -v175, v150, v197
    v_fma_f32 v184, v176, v150, -v196
    v_fma_f32 v192, -v176, v150, v197
    v_fma_f32 v185, v177, v150, -v196
    v_fma_f32 v193, -v177, v150, v197
    v_fma_f32 v186, v178, v150, -v196
    v_fma_f32 v194, -v178, v150, v197
    v_fma_f32 v187, v179, v150, -v196
    v_fma_f32 v195, -v179, v150, v197
    v_exp_f32 v180, v180
    v_exp_f32 v188, v188
    v_exp_f32 v181, v181
    v_exp_f32 v189, v189
    v_exp_f32 v182, v182
    v_exp_f32 v190, v190
    v_exp_f32 v183, v183
    v_exp_f32 v191, v191
    v_exp_f32 v184, v184
    v_exp_f32 v192, v192
    v_exp_f32 v185, v185
    v_exp_f32 v193, v193
    v_exp_f32 v186, v186
    v_exp_f32 v194, v194
    v_exp_f32 v187, v187
    v_exp_f32 v195, v195
    v_cndmask_b32 v184, v184, 0, s[40:41]
    v_cndmask_b32 v192, v192, 0, s[40:41]
    v_cndmask_b32 v185, v185, 0, s[40:41]
    v_cndmask_b32 v193, v193, 0, s[40:41]
    v_cndmask_b32 v186, v186, 0, s[40:41]
    v_cndmask_b32 v194, v194, 0, s[40:41]
    v_cndmask_b32 v187, v187, 0, s[40:41]
    v_cndmask_b32 v195, v195, 0, s[40:41]
    v_add_f32 v196, v180, v181
    v_add_f32 v197, v188, v189
    v_add_f32 v196, v196, v182
    v_add_f32 v197, v197, v190
    v_add_f32 v196, v196, v183
    v_add_f32 v197, v197, v191
    v_add_f32 v196, v196, v184
    v_add_f32 v197, v197, v192
    v_add_f32 v196, v196, v185
    v_add_f32 v197, v197, v193
    v_add_f32 v196, v196, v186
    v_add_f32 v197, v197, v194
    v_add_f32 v196, v196, v187
    v_add_f32 v197, v197, v195
    v_mov_b32 v198, v196
    v_mov_b32 v199, v197
    s_nop 0
    v_permlane16_swap_b32 v196, v198
    v_permlane16_swap_b32 v197, v199
    v_add_f32 v196, v196, v198
    v_add_f32 v197, v197, v199
    v_mov_b32 v198, v196
    v_mov_b32 v199, v197
    s_nop 0
    v_permlane32_swap_b32 v196, v198
    v_permlane32_swap_b32 v197, v199
    v_add_f32 v196, v196, v198
    v_add_f32 v197, v197, v199
    v_rcp_f32 v196, v196
    v_rcp_f32 v197, v197
    v_mul_f32 v180, v180, v196
    v_mul_f32 v188, v188, v197
    v_mul_f32 v181, v181, v196
    v_mul_f32 v189, v189, v197
    v_mul_f32 v182, v182, v196
    v_mul_f32 v190, v190, v197
    v_mul_f32 v183, v183, v196
    v_mul_f32 v191, v191, v197
    v_mul_f32 v184, v184, v196
    v_mul_f32 v192, v192, v197
    v_mul_f32 v185, v185, v196
    v_mul_f32 v193, v193, v197
    v_mul_f32 v186, v186, v196
    v_mul_f32 v194, v194, v197
    v_mul_f32 v187, v187, v196
    v_mul_f32 v195, v195, v197
    v_cvt_pk_bf16_f32 v16, v180, v181
    v_cvt_pk_bf16_f32 v20, v188, v189
    v_cvt_pk_bf16_f32 v17, v182, v183
    v_cvt_pk_bf16_f32 v21, v190, v191
    v_cvt_pk_bf16_f32 v18, v184, v185
    v_cvt_pk_bf16_f32 v22, v192, v193
    v_cvt_pk_bf16_f32 v19, v186, v187
    v_cvt_pk_bf16_f32 v23, v194, v195
    s_lshl_b32 s34, s23, 8
    s_add_u32 s34, s34, s53
    s_add_u32 s34, s34, 16384
    s_add_u32 s35, s53, 20480
    s_and_b32 s49, s2, 15
    s_lshl_b32 s49, s49, 8
    s_add_u32 s49, s49, s35
    s_waitcnt vmcnt(0)
    s_barrier
    s_cmp_lg_u32 s3, 0
    s_cbranch_scc1 kv_pub_skip
    v_mov_b32 v1, 0
    v_mov_b32 v2, 1
    s_mov_b64 s[58:59], exec
    s_mov_b64 exec, 1
    buffer_atomic_add v2, v1, s[8:11], s34 offen sc0 sc1
    s_waitcnt vmcnt(0)
    v_readfirstlane_b32 s57, v2
    s_mov_b64 exec, s[58:59]
    v_and_b32 v1, 63, v0
    s_cmp_lg_u32 s57, 15
    s_cbranch_scc1 kv_pub_skip
    v_lshlrev_b32 v9, 8, v1
    v_mov_b32 v2, 1
    s_mov_b64 exec, 0xffff
    buffer_atomic_add v2, v9, s[8:11], s35 offen sc1
    s_mov_b64 exec, s[58:59]
kv_pub_skip:
    s_nop 4
    s_cmp_lg_u32 s3, 7
    s_cbranch_scc1 sync_skip_kv
    v_mov_b32 v1, 0
    s_mov_b64 s[58:59], exec
    s_mov_b64 exec, 1
    s_mov_b32 s56, 0
sync_poll_kv:
    buffer_load_dword v2, v1, s[8:11], s49 offen sc1
    s_waitcnt vmcnt(0)
    v_readfirstlane_b32 s57, v2
    s_nop 0
    s_cmp_ge_u32 s57, 16
    s_cbranch_scc1 sync_done_kv
    s_sleep 1
    s_add_u32 s56, s56, 1
    s_cmp_lt_u32 s56, 0x8000
    s_cbranch_scc1 sync_poll_kv
sync_done_kv:
    s_mov_b64 exec, s[58:59]
    v_and_b32 v1, 63, v0
sync_skip_kv:
    s_nop 4
    s_barrier
    s_lshl_b32 s28, s23, 13
    s_add_u32 s28, s28, s54
    s_add_u32 s29, s28, 4096
    buffer_load_dwordx4 v[64:67], v5, s[8:11], s28 offen offset:0 sc1
    buffer_load_dwordx4 v[68:71], v5, s[8:11], s28 offen offset:2048 sc1
    buffer_load_dwordx4 v[72:75], v5, s[8:11], s28 offen offset:1024 sc1
    buffer_load_dwordx4 v[76:79], v5, s[8:11], s28 offen offset:3072 sc1
    buffer_load_dwordx4 v[80:83], v5, s[8:11], s29 offen offset:0 sc1
    buffer_load_dwordx4 v[84:87], v5, s[8:11], s29 offen offset:2048 sc1
    buffer_load_dwordx4 v[88:91], v5, s[8:11], s29 offen offset:1024 sc1
    buffer_load_dwordx4 v[92:95], v5, s[8:11], s29 offen offset:3072 sc1
    s_lshl_b32 s33, s24, 4
    s_add_u32 s33, s33, s23
    s_lshl_b32 s33, s33, 10
    s_add_u32 s33, s33, s83
    s_lshl_b32 s50, s22, 8
    s_add_u32 s50, s50, s53
    s_add_u32 s50, s50, 12288
    s_waitcnt vmcnt(0)
    v_cvt_pk_bf16_f32 v64, v64, v65
    v_cvt_pk_bf16_f32 v65, v66, v67
    v_cvt_pk_bf16_f32 v66, v68, v69
    v_cvt_pk_bf16_f32 v67, v70, v71
    v_cvt_pk_bf16_f32 v68, v72, v73
    v_cvt_pk_bf16_f32 v69, v74, v75
    v_cvt_pk_bf16_f32 v70, v76, v77
    v_cvt_pk_bf16_f32 v71, v78, v79
    v_cvt_pk_bf16_f32 v72, v80, v81
    v_cvt_pk_bf16_f32 v73, v82, v83
    v_cvt_pk_bf16_f32 v74, v84, v85
    v_cvt_pk_bf16_f32 v75, v86, v87
    v_cvt_pk_bf16_f32 v76, v88, v89
    v_cvt_pk_bf16_f32 v77, v90, v91
    v_cvt_pk_bf16_f32 v78, v92, v93
    v_cvt_pk_bf16_f32 v79, v94, v95
    v_mfma_f32_16x16x32_bf16 v[80:83], v[64:67], v[16:19], 0
    v_mfma_f32_16x16x32_bf16 v[80:83], v[72:75], v[20:23], v[80:83]
    v_mfma_f32_16x16x32_bf16 v[84:87], v[68:71], v[16:19], 0
    v_mfma_f32_16x16x32_bf16 v[84:87], v[76:79], v[20:23], v[84:87]
    s_nop 7
    v_cndmask_b32 v88, 0, v84, s[40:41]
    v_mov_b32 v89, v88
    s_nop 1
    v_permlane16_swap_b32 v88, v89
    v_add_f32 v88, v88, v89
    v_mov_b32 v89, v88
    s_nop 1
    v_permlane32_swap_b32 v88, v89
    v_add_f32 v88, v88, v89
    v_add_f32 v88, 0x358637bd, v88
    v_rcp_f32 v88, v88
    s_nop 0
    v_mul_f32 v80, v80, v88
    v_mul_f32 v81, v81, v88
    v_mul_f32 v82, v82, v88
    v_mul_f32 v83, v83, v88
    v_mul_f32 v84, v84, v88
    v_mul_f32 v85, v85, v88
    v_mul_f32 v86, v86, v88
    v_mul_f32 v87, v87, v88
    v_cvt_pk_bf16_f32 v92, v80, v81
    v_cvt_pk_bf16_f32 v93, v82, v83
    v_cvt_pk_bf16_f32 v94, v84, v85
    v_cvt_pk_bf16_f32 v95, v86, v87
    buffer_store_dwordx4 v[92:95], v5, s[8:11], s33 offen sc1
    s_waitcnt vmcnt(0)
    s_barrier
    s_cmp_lg_u32 s3, 0
    s_cbranch_scc1 pub_skip_o
    v_mov_b32 v1, 0
    v_mov_b32 v2, 1
    s_mov_b64 s[58:59], exec
    s_mov_b64 exec, 1
    buffer_atomic_add v2, v1, s[8:11], s50 offen sc1
    s_mov_b64 exec, s[58:59]
    v_and_b32 v1, 63, v0
pub_skip_o:
    s_nop 4
    s_cmp_ge_u32 s2, 224
    s_cbranch_scc1 kb_tail
    s_branch kb_body
kb_body:
    s_nop 7
    s_nop 7
    s_and_b32 s20, s2, 7
    s_lshr_b32 s21, s2, 3
    s_lshl_b32 s22, s20, 2
    s_and_b32 s23, s21, 3
    s_add_u32 s22, s22, s23
    s_lshr_b32 s23, s21, 2
    s_lshr_b32 s24, s3, 1
    s_lshl_b32 s25, s22, 2
    s_add_u32 s24, s24, s25
    s_and_b32 s25, s3, 1
    s_lshl_b32 s26, s23, 1
    s_add_u32 s25, s25, s26
    s_mul_i32 s26, s24, 14
    s_add_u32 s26, s26, s25
    s_lshl_b32 s27, s3, 1
    s_mul_i32 s30, s27, 28
    s_lshl_b32 s31, s23, 2
    s_add_u32 s30, s30, s31
    s_lshl_b32 s30, s30, 10
    s_add_u32 s30, s30, 0x170000
    s_add_u32 s31, s30, 28672
    buffer_load_dwordx4 v[80:83], v5, s[8:11], s30 offen offset:0
    buffer_load_dwordx4 v[84:87], v5, s[8:11], s30 offen offset:1024
    buffer_load_dwordx4 v[88:91], v5, s[8:11], s30 offen offset:2048
    buffer_load_dwordx4 v[92:95], v5, s[8:11], s30 offen offset:3072
    buffer_load_dwordx4 v[96:99], v5, s[8:11], s31 offen offset:0
    buffer_load_dwordx4 v[100:103], v5, s[8:11], s31 offen offset:1024
    buffer_load_dwordx4 v[104:107], v5, s[8:11], s31 offen offset:2048
    buffer_load_dwordx4 v[108:111], v5, s[8:11], s31 offen offset:3072
    s_lshl_b32 s30, s26, 10
    s_add_u32 s30, s30, s52
    buffer_load_dwordx4 v[12:15], v5, s[8:11], s30 offen sc1
    s_lshr_b32 s49, s22, 1
    s_lshl_b32 s49, s49, 8
    s_add_u32 s49, s49, s53
    s_add_u32 s49, s49, 12288
    s_cmp_lg_u32 s3, 7
    s_cbranch_scc1 sync_skip_o
    v_mov_b32 v1, 0
    s_mov_b64 s[58:59], exec
    s_mov_b64 exec, 1
    s_mov_b32 s56, 0
sync_poll_o:
    buffer_load_dword v2, v1, s[8:11], s49 offen sc1
    s_waitcnt vmcnt(0)
    v_readfirstlane_b32 s57, v2
    s_nop 0
    s_cmp_ge_u32 s57, 16
    s_cbranch_scc1 sync_done_o
    s_sleep 1
    s_add_u32 s56, s56, 1
    s_cmp_lt_u32 s56, 0x8000
    s_cbranch_scc1 sync_poll_o
sync_done_o:
    s_mov_b64 exec, s[58:59]
    v_and_b32 v1, 63, v0
sync_skip_o:
    s_nop 4
    s_barrier
    s_lshl_b32 s30, s22, 6
    s_add_u32 s30, s30, s27
    s_lshl_b32 s30, s30, 10
    s_add_u32 s30, s30, s83
    s_add_u32 s31, s30, 0
    buffer_load_dwordx4 v[112:115], v5, s[8:11], s31 offen offset:0 sc1
    buffer_load_dwordx4 v[128:131], v5, s[8:11], s31 offen offset:1024 sc1
    s_add_u32 s31, s30, 16384
    buffer_load_dwordx4 v[116:119], v5, s[8:11], s31 offen offset:0 sc1
    buffer_load_dwordx4 v[132:135], v5, s[8:11], s31 offen offset:1024 sc1
    s_add_u32 s31, s30, 32768
    buffer_load_dwordx4 v[120:123], v5, s[8:11], s31 offen offset:0 sc1
    buffer_load_dwordx4 v[136:139], v5, s[8:11], s31 offen offset:1024 sc1
    s_add_u32 s31, s30, 49152
    buffer_load_dwordx4 v[124:127], v5, s[8:11], s31 offen offset:0 sc1
    buffer_load_dwordx4 v[140:143], v5, s[8:11], s31 offen offset:1024 sc1
    s_waitcnt vmcnt(6)
    v_mfma_f32_16x16x32_bf16 v[16:19], v[80:83], v[112:115], 0
    v_mfma_f32_16x16x32_bf16 v[20:23], v[84:87], v[112:115], 0
    v_mfma_f32_16x16x32_bf16 v[24:27], v[88:91], v[112:115], 0
    v_mfma_f32_16x16x32_bf16 v[28:31], v[92:95], v[112:115], 0
    v_mfma_f32_16x16x32_bf16 v[16:19], v[96:99], v[128:131], v[16:19]
    v_mfma_f32_16x16x32_bf16 v[20:23], v[100:103], v[128:131], v[20:23]
    v_mfma_f32_16x16x32_bf16 v[24:27], v[104:107], v[128:131], v[24:27]
    v_mfma_f32_16x16x32_bf16 v[28:31], v[108:111], v[128:131], v[28:31]
    s_waitcnt vmcnt(4)
    v_mfma_f32_16x16x32_bf16 v[32:35], v[80:83], v[116:119], 0
    v_mfma_f32_16x16x32_bf16 v[36:39], v[84:87], v[116:119], 0
    v_mfma_f32_16x16x32_bf16 v[40:43], v[88:91], v[116:119], 0
    v_mfma_f32_16x16x32_bf16 v[44:47], v[92:95], v[116:119], 0
    v_mfma_f32_16x16x32_bf16 v[32:35], v[96:99], v[132:135], v[32:35]
    v_mfma_f32_16x16x32_bf16 v[36:39], v[100:103], v[132:135], v[36:39]
    v_mfma_f32_16x16x32_bf16 v[40:43], v[104:107], v[132:135], v[40:43]
    v_mfma_f32_16x16x32_bf16 v[44:47], v[108:111], v[132:135], v[44:47]
    s_waitcnt vmcnt(2)
    v_mfma_f32_16x16x32_bf16 v[48:51], v[80:83], v[120:123], 0
    v_mfma_f32_16x16x32_bf16 v[52:55], v[84:87], v[120:123], 0
    v_mfma_f32_16x16x32_bf16 v[56:59], v[88:91], v[120:123], 0
    v_mfma_f32_16x16x32_bf16 v[60:63], v[92:95], v[120:123], 0
    v_mfma_f32_16x16x32_bf16 v[48:51], v[96:99], v[136:139], v[48:51]
    v_mfma_f32_16x16x32_bf16 v[52:55], v[100:103], v[136:139], v[52:55]
    v_mfma_f32_16x16x32_bf16 v[56:59], v[104:107], v[136:139], v[56:59]
    v_mfma_f32_16x16x32_bf16 v[60:63], v[108:111], v[136:139], v[60:63]
    s_waitcnt vmcnt(0)
    v_mfma_f32_16x16x32_bf16 v[64:67], v[80:83], v[124:127], 0
    v_mfma_f32_16x16x32_bf16 v[68:71], v[84:87], v[124:127], 0
    v_mfma_f32_16x16x32_bf16 v[72:75], v[88:91], v[124:127], 0
    v_mfma_f32_16x16x32_bf16 v[76:79], v[92:95], v[124:127], 0
    v_mfma_f32_16x16x32_bf16 v[64:67], v[96:99], v[140:143], v[64:67]
    v_mfma_f32_16x16x32_bf16 v[68:71], v[100:103], v[140:143], v[68:71]
    v_mfma_f32_16x16x32_bf16 v[72:75], v[104:107], v[140:143], v[72:75]
    v_mfma_f32_16x16x32_bf16 v[76:79], v[108:111], v[140:143], v[76:79]
    s_lshl_b32 s33, s3, 14
    v_add_u32 v9, s33, v5
    ds_write_b128 v9, v[16:19] offset:0
    ds_write_b128 v9, v[20:23] offset:1024
    ds_write_b128 v9, v[24:27] offset:2048
    ds_write_b128 v9, v[28:31] offset:3072
    ds_write_b128 v9, v[32:35] offset:4096
    ds_write_b128 v9, v[36:39] offset:5120
    ds_write_b128 v9, v[40:43] offset:6144
    ds_write_b128 v9, v[44:47] offset:7168
    ds_write_b128 v9, v[48:51] offset:8192
    ds_write_b128 v9, v[52:55] offset:9216
    ds_write_b128 v9, v[56:59] offset:10240
    ds_write_b128 v9, v[60:63] offset:11264
    ds_write_b128 v9, v[64:67] offset:12288
    ds_write_b128 v9, v[68:71] offset:13312
    ds_write_b128 v9, v[72:75] offset:14336
    ds_write_b128 v9, v[76:79] offset:15360
    s_lshl_b32 s33, s3, 11
    v_add_u32 v9, s33, v5
    v_add_u32 v10, 0x10000, v9
    s_lshl_b32 s34, s26, 10
    s_add_u32 s34, s34, s80
    s_lshl_b32 s35, s26, 7
    s_add_u32 s35, s35, s81
    v_lshlrev_b32 v8, 3, v3
    v_mov_b32 v11, 0x3f803f80
    s_waitcnt lgkmcnt(0)
    s_barrier
    ds_read_b128 v[16:19], v9 offset:0
    ds_read_b128 v[20:23], v9 offset:1024
    ds_read_b128 v[24:27], v9 offset:16384
    ds_read_b128 v[28:31], v9 offset:17408
    ds_read_b128 v[32:35], v9 offset:32768
    ds_read_b128 v[36:39], v9 offset:33792
    ds_read_b128 v[40:43], v9 offset:49152
    ds_read_b128 v[44:47], v9 offset:50176
    ds_read_b128 v[48:51], v10 offset:0
    ds_read_b128 v[52:55], v10 offset:1024
    ds_read_b128 v[56:59], v10 offset:16384
    ds_read_b128 v[60:63], v10 offset:17408
    ds_read_b128 v[64:67], v10 offset:32768
    ds_read_b128 v[68:71], v10 offset:33792
    ds_read_b128 v[72:75], v10 offset:49152
    ds_read_b128 v[76:79], v10 offset:50176
    s_waitcnt lgkmcnt(8)
    v_add_f32 v16, v16, v32
    v_add_f32 v17, v17, v33
    v_add_f32 v18, v18, v34
    v_add_f32 v19, v19, v35
    v_add_f32 v20, v20, v36
    v_add_f32 v21, v21, v37
    v_add_f32 v22, v22, v38
    v_add_f32 v23, v23, v39
    v_add_f32 v24, v24, v40
    v_add_f32 v25, v25, v41
    v_add_f32 v26, v26, v42
    v_add_f32 v27, v27, v43
    v_add_f32 v28, v28, v44
    v_add_f32 v29, v29, v45
    v_add_f32 v30, v30, v46
    v_add_f32 v31, v31, v47
    s_waitcnt lgkmcnt(0)
    v_add_f32 v48, v48, v64
    v_add_f32 v49, v49, v65
    v_add_f32 v50, v50, v66
    v_add_f32 v51, v51, v67
    v_add_f32 v52, v52, v68
    v_add_f32 v53, v53, v69
    v_add_f32 v54, v54, v70
    v_add_f32 v55, v55, v71
    v_add_f32 v56, v56, v72
    v_add_f32 v57, v57, v73
    v_add_f32 v58, v58, v74
    v_add_f32 v59, v59, v75
    v_add_f32 v60, v60, v76
    v_add_f32 v61, v61, v77
    v_add_f32 v62, v62, v78
    v_add_f32 v63, v63, v79
    v_add_f32 v16, v16, v24
    v_add_f32 v48, v48, v56
    v_add_f32 v17, v17, v25
    v_add_f32 v49, v49, v57
    v_add_f32 v18, v18, v26
    v_add_f32 v50, v50, v58
    v_add_f32 v19, v19, v27
    v_add_f32 v51, v51, v59
    v_add_f32 v20, v20, v28
    v_add_f32 v52, v52, v60
    v_add_f32 v21, v21, v29
    v_add_f32 v53, v53, v61
    v_add_f32 v22, v22, v30
    v_add_f32 v54, v54, v62
    v_add_f32 v23, v23, v31
    v_add_f32 v55, v55, v63
    v_add_f32 v16, v16, v48
    v_add_f32 v17, v17, v49
    v_add_f32 v18, v18, v50
    v_add_f32 v19, v19, v51
    v_add_f32 v20, v20, v52
    v_add_f32 v21, v21, v53
    v_add_f32 v22, v22, v54
    v_add_f32 v23, v23, v55
    s_waitcnt vmcnt(8)
    v_cvt_pk_bf16_f32 v24, v16, v17
    v_cvt_pk_bf16_f32 v25, v18, v19
    v_cvt_pk_bf16_f32 v26, v20, v21
    v_cvt_pk_bf16_f32 v27, v22, v23
    v_lshlrev_b32 v16, 16, v24
    v_and_b32 v17, 0xffff0000, v24
    v_lshlrev_b32 v32, 16, v12
    v_and_b32 v33, 0xffff0000, v12
    v_lshlrev_b32 v18, 16, v25
    v_and_b32 v19, 0xffff0000, v25
    v_lshlrev_b32 v34, 16, v13
    v_and_b32 v35, 0xffff0000, v13
    v_lshlrev_b32 v20, 16, v26
    v_and_b32 v21, 0xffff0000, v26
    v_lshlrev_b32 v36, 16, v14
    v_and_b32 v37, 0xffff0000, v14
    v_lshlrev_b32 v22, 16, v27
    v_and_b32 v23, 0xffff0000, v27
    v_lshlrev_b32 v38, 16, v15
    v_and_b32 v39, 0xffff0000, v15
    v_add_f32 v16, v16, v32
    v_add_f32 v17, v17, v33
    v_add_f32 v18, v18, v34
    v_add_f32 v19, v19, v35
    v_add_f32 v20, v20, v36
    v_add_f32 v21, v21, v37
    v_add_f32 v22, v22, v38
    v_add_f32 v23, v23, v39
    v_cvt_pk_bf16_f32 v24, v16, v17
    v_cvt_pk_bf16_f32 v25, v18, v19
    v_cvt_pk_bf16_f32 v26, v20, v21
    v_cvt_pk_bf16_f32 v27, v22, v23
    buffer_store_dwordx4 v[24:27], v5, s[8:11], s34 offen sc1
    v_mov_b32 v40, 0
    v_mov_b32 v41, 0
    v_dot2c_f32_bf16 v40, v24, v11
    v_dot2c_f32_bf16 v41, v24, v24
    v_dot2c_f32_bf16 v40, v25, v11
    v_dot2c_f32_bf16 v41, v25, v25
    v_dot2c_f32_bf16 v40, v26, v11
    v_dot2c_f32_bf16 v41, v26, v26
    v_dot2c_f32_bf16 v40, v27, v11
    v_dot2c_f32_bf16 v41, v27, v27
    s_nop 1
    v_mov_b32 v42, v40
    v_mov_b32 v43, v41
    s_nop 0
    v_permlane16_swap_b32 v40, v42
    v_permlane16_swap_b32 v41, v43
    v_add_f32 v40, v40, v42
    v_add_f32 v41, v41, v43
    v_mov_b32 v42, v40
    v_mov_b32 v43, v41
    s_nop 0
    v_permlane32_swap_b32 v40, v42
    v_permlane32_swap_b32 v41, v43
    v_add_f32 v40, v40, v42
    v_add_f32 v41, v41, v43
    buffer_store_dwordx2 v[40:41], v8, s[8:11], s35 offen sc1
    s_lshr_b32 s50, s22, 1
    s_lshl_b32 s50, s50, 8
    s_add_u32 s50, s50, s53
    s_add_u32 s51, s50, 4096
    s_waitcnt vmcnt(0)
    s_barrier
    s_cmp_lg_u32 s3, 0
    s_cbranch_scc1 pub_skip_a
    v_mov_b32 v1, 0
    v_mov_b32 v2, 1
    s_mov_b64 s[58:59], exec
    s_mov_b64 exec, 1
    buffer_atomic_add v2, v1, s[8:11], s50 offen sc1
    s_mov_b64 exec, s[58:59]
    v_and_b32 v1, 63, v0
pub_skip_a:
    s_nop 4
    s_and_b32 s22, s20, 3
    s_lshl_b32 s22, s22, 2
    s_and_b32 s23, s21, 3
    s_add_u32 s22, s22, s23
    s_lshr_b32 s23, s20, 2
    s_mul_i32 s23, s23, 7
    s_lshr_b32 s24, s21, 2
    s_add_u32 s23, s23, s24
    s_lshl_b32 s23, s23, 3
    s_add_u32 s23, s23, s3
    s_lshl_b32 s24, s22, 3
    s_add_u32 s24, s24, s3
    s_mul_i32 s26, s3, 14336
    s_mul_i32 s27, s24, 14336
    s_add_u32 s27, s27, s80
    s_mul_i32 s29, s23, 28672
    s_add_u32 s29, s29, 0x1e0000
    s_add_u32 s42, s29, 0
    s_add_u32 s43, s29, 4096
    s_add_u32 s44, s29, 8192
    s_add_u32 s45, s29, 12288
    s_add_u32 s46, s29, 16384
    s_add_u32 s47, s29, 20480
    s_add_u32 s48, s29, 24576
    buffer_load_dwordx4 v[136:139], v5, s[8:11], s42 offen offset:0
    buffer_load_dwordx4 v[140:143], v5, s[8:11], s42 offen offset:1024
    buffer_load_dwordx4 v[144:147], v5, s[8:11], s42 offen offset:2048
    buffer_load_dwordx4 v[148:151], v5, s[8:11], s42 offen offset:3072
    buffer_load_dwordx4 v[152:155], v5, s[8:11], s43 offen offset:0
    buffer_load_dwordx4 v[156:159], v5, s[8:11], s43 offen offset:1024
    s_lshl_b32 s31, s23, 11
    s_add_u32 s31, s31, 0x4f0000
    buffer_load_dwordx4 v[248:251], v5, s[8:11], s31 offen
    buffer_load_dwordx4 v[252:255], v5, s[8:11], s31 offen offset:1024
    s_lshr_b32 s38, s21, 2
    s_mul_i32 s28, s38, 224
    s_mul_i32 s39, s3, 7
    s_add_u32 s28, s28, s39
    s_lshl_b32 s28, s28, 10
    s_add_u32 s28, s28, 0x528000
    s_add_u32 s84, s28, 0
    s_add_u32 s88, s28, 4096
    s_add_u32 s85, s28, 57344
    s_add_u32 s89, s28, 61440
    s_add_u32 s86, s28, 114688
    s_add_u32 s90, s28, 118784
    s_add_u32 s87, s28, 172032
    s_add_u32 s91, s28, 176128
    s_lshl_b32 s49, s22, 8
    s_add_u32 s49, s49, s53
    s_cmp_lg_u32 s3, 7
    s_cbranch_scc1 sync_skip_a
    v_mov_b32 v1, 0
    s_mov_b64 s[58:59], exec
    s_mov_b64 exec, 1
    s_mov_b32 s56, 0
sync_poll_a:
    buffer_load_dword v2, v1, s[8:11], s49 offen sc1
    s_waitcnt vmcnt(0)
    v_readfirstlane_b32 s57, v2
    s_nop 0
    s_cmp_ge_u32 s57, 14
    s_cbranch_scc1 sync_done_a
    s_sleep 1
    s_add_u32 s56, s56, 1
    s_cmp_lt_u32 s56, 0x8000
    s_cbranch_scc1 sync_poll_a
sync_done_a:
    s_mov_b64 exec, s[58:59]
    v_and_b32 v1, 63, v0
sync_skip_a:
    s_nop 4
    s_barrier
    v_lshlrev_b32 v6, 7, v4
    v_lshlrev_b32 v2, 3, v3
    v_add_u32 v6, v6, v2
    v_mov_b32 v2, 0x40000000
    v_cmp_gt_u32 vcc, 2, v4
    s_nop 1
    v_cndmask_b32 v7, v2, v6, vcc
    s_add_u32 s28, s26, 0
    s_mov_b32 m0, s28
    s_add_u32 s29, s27, 0
    buffer_load_dwordx4 v5, s[8:11], s29 offen offset:0 sc1 lds
    buffer_load_dwordx4 v5, s[8:11], s29 offen offset:1024 sc1 lds
    buffer_load_dwordx4 v5, s[8:11], s29 offen offset:2048 sc1 lds
    buffer_load_dwordx4 v5, s[8:11], s29 offen offset:3072 sc1 lds
    s_add_u32 s28, s26, 4096
    s_mov_b32 m0, s28
    s_add_u32 s29, s27, 4096
    buffer_load_dwordx4 v5, s[8:11], s29 offen offset:0 sc1 lds
    buffer_load_dwordx4 v5, s[8:11], s29 offen offset:1024 sc1 lds
    buffer_load_dwordx4 v5, s[8:11], s29 offen offset:2048 sc1 lds
    s_mul_i32 s30, s24, 1792
    s_add_u32 s30, s30, s81
    buffer_load_dwordx2 v[8:9], v6, s[8:11], s30 offen offset:0 sc1
    buffer_load_dwordx2 v[10:11], v6, s[8:11], s30 offen offset:512 sc1
    buffer_load_dwordx2 v[12:13], v6, s[8:11], s30 offen offset:1024 sc1
    buffer_load_dwordx2 v[14:15], v7, s[8:11], s30 offen offset:1536 sc1
    s_add_u32 s28, s26, 7168
    s_mov_b32 m0, s28
    s_add_u32 s29, s27, 7168
    buffer_load_dwordx4 v5, s[8:11], s29 offen offset:0 sc1 lds
    buffer_load_dwordx4 v5, s[8:11], s29 offen offset:1024 sc1 lds
    buffer_load_dwordx4 v5, s[8:11], s29 offen offset:2048 sc1 lds
    buffer_load_dwordx4 v5, s[8:11], s29 offen offset:3072 sc1 lds
    s_add_u32 s28, s26, 11264
    s_mov_b32 m0, s28
    s_add_u32 s29, s27, 11264
    buffer_load_dwordx4 v5, s[8:11], s29 offen offset:0 sc1 lds
    buffer_load_dwordx4 v5, s[8:11], s29 offen offset:1024 sc1 lds
    buffer_load_dwordx4 v5, s[8:11], s29 offen offset:2048 sc1 lds
    v_add_u32 v6, 57344, v5
    s_waitcnt vmcnt(7)
    v_add_f32 v8, v8, v10
    v_add_f32 v9, v9, v11
    v_add_f32 v12, v12, v14
    v_add_f32 v13, v13, v15
    v_add_f32 v8, v8, v12
    v_add_f32 v9, v9, v13
    v_mov_b32 v16, v8
    v_mov_b32 v17, v9
    s_nop 0
    v_permlane16_swap_b32 v8, v16
    v_permlane16_swap_b32 v9, v17
    v_add_f32 v8, v8, v16
    v_add_f32 v9, v9, v17
    v_mov_b32 v16, v8
    v_mov_b32 v17, v9
    s_nop 0
    v_permlane32_swap_b32 v8, v16
    v_permlane32_swap_b32 v9, v17
    v_add_f32 v8, v8, v16
    v_add_f32 v9, v9, v17
    v_mul_f32 v8, 0x3b124925, v8
    v_mul_f32 v9, 0x3b124925, v9
    v_fma_f32 v9, -v8, v8, v9
    v_max_f32 v9, 0, v9
    v_cvt_pk_bf16_f32 v16, v8, v9
    v_lshlrev_b32 v18, 16, v16
    v_and_b32 v17, 0xffff0000, v16
    v_add_f32 v17, 0x3727c5ac, v17
    v_cvt_pk_bf16_f32 v16, v17, v17
    v_lshlrev_b32 v17, 16, v16
    v_sqrt_f32 v17, v17
    s_nop 0
    v_cvt_pk_bf16_f32 v16, v17, v17
    v_lshlrev_b32 v17, 16, v16
    v_rcp_f32 v19, v17
    s_lshl_b32 s33, s3, 7
    s_add_u32 s33, s33, 114688
    v_lshlrev_b32 v2, 3, v3
    v_add_u32 v2, s33, v2
    ds_write_b64 v2, v[18:19]
    s_waitcnt lgkmcnt(0)
    s_barrier
    ds_read_b128 v[72:75], v5 offset:0
    ds_read_b128 v[76:79], v5 offset:14336
    ds_read_b128 v[80:83], v5 offset:28672
    ds_read_b128 v[84:87], v5 offset:43008
    ds_read_b128 v[88:91], v6 offset:0
    ds_read_b128 v[92:95], v6 offset:14336
    ds_read_b128 v[96:99], v6 offset:28672
    ds_read_b128 v[100:103], v6 offset:43008
    ds_read_b128 v[104:107], v5 offset:1024
    ds_read_b128 v[108:111], v5 offset:15360
    ds_read_b128 v[112:115], v5 offset:29696
    ds_read_b128 v[116:119], v5 offset:44032
    ds_read_b128 v[120:123], v6 offset:1024
    ds_read_b128 v[124:127], v6 offset:15360
    ds_read_b128 v[128:131], v6 offset:29696
    ds_read_b128 v[132:135], v6 offset:44032
    s_waitcnt vmcnt(24) lgkmcnt(8)
    v_mfma_f32_16x16x32_bf16 v[8:11], v[136:139], v[72:75], 0
    v_mfma_f32_16x16x32_bf16 v[12:15], v[140:143], v[72:75], 0
    v_mfma_f32_16x16x32_bf16 v[16:19], v[136:139], v[76:79], 0
    v_mfma_f32_16x16x32_bf16 v[20:23], v[140:143], v[76:79], 0
    buffer_load_dwordx4 v[160:163], v5, s[8:11], s43 offen offset:2048
    buffer_load_dwordx4 v[164:167], v5, s[8:11], s43 offen offset:3072
    v_mfma_f32_16x16x32_bf16 v[24:27], v[136:139], v[80:83], 0
    v_mfma_f32_16x16x32_bf16 v[28:31], v[140:143], v[80:83], 0
    v_mfma_f32_16x16x32_bf16 v[32:35], v[136:139], v[84:87], 0
    v_mfma_f32_16x16x32_bf16 v[36:39], v[140:143], v[84:87], 0
    v_mfma_f32_16x16x32_bf16 v[40:43], v[136:139], v[88:91], 0
    v_mfma_f32_16x16x32_bf16 v[44:47], v[140:143], v[88:91], 0
    v_mfma_f32_16x16x32_bf16 v[48:51], v[136:139], v[92:95], 0
    v_mfma_f32_16x16x32_bf16 v[52:55], v[140:143], v[92:95], 0
    v_mfma_f32_16x16x32_bf16 v[56:59], v[136:139], v[96:99], 0
    v_mfma_f32_16x16x32_bf16 v[60:63], v[140:143], v[96:99], 0
    v_mfma_f32_16x16x32_bf16 v[64:67], v[136:139], v[100:103], 0
    v_mfma_f32_16x16x32_bf16 v[68:71], v[140:143], v[100:103], 0
    ds_read_b128 v[72:75], v5 offset:2048
    ds_read_b128 v[76:79], v5 offset:16384
    ds_read_b128 v[80:83], v5 offset:30720
    ds_read_b128 v[84:87], v5 offset:45056
    ds_read_b128 v[88:91], v6 offset:2048
    ds_read_b128 v[92:95], v6 offset:16384
    ds_read_b128 v[96:99], v6 offset:30720
    ds_read_b128 v[100:103], v6 offset:45056
    s_waitcnt vmcnt(24) lgkmcnt(8)
    v_mfma_f32_16x16x32_bf16 v[8:11], v[144:147], v[104:107], v[8:11]
    v_mfma_f32_16x16x32_bf16 v[12:15], v[148:151], v[104:107], v[12:15]
    v_mfma_f32_16x16x32_bf16 v[16:19], v[144:147], v[108:111], v[16:19]
    v_mfma_f32_16x16x32_bf16 v[20:23], v[148:151], v[108:111], v[20:23]
    buffer_load_dwordx4 v[168:171], v5, s[8:11], s44 offen offset:0
    buffer_load_dwordx4 v[172:175], v5, s[8:11], s44 offen offset:1024
    v_mfma_f32_16x16x32_bf16 v[24:27], v[144:147], v[112:115], v[24:27]
    v_mfma_f32_16x16x32_bf16 v[28:31], v[148:151], v[112:115], v[28:31]
    v_mfma_f32_16x16x32_bf16 v[32:35], v[144:147], v[116:119], v[32:35]
    v_mfma_f32_16x16x32_bf16 v[36:39], v[148:151], v[116:119], v[36:39]
    buffer_load_dwordx4 v[136:139], v5, s[8:11], s84 offen offset:0
    v_mfma_f32_16x16x32_bf16 v[40:43], v[144:147], v[120:123], v[40:43]
    v_mfma_f32_16x16x32_bf16 v[44:47], v[148:151], v[120:123], v[44:47]
    v_mfma_f32_16x16x32_bf16 v[48:51], v[144:147], v[124:127], v[48:51]
    v_mfma_f32_16x16x32_bf16 v[52:55], v[148:151], v[124:127], v[52:55]
    buffer_load_dwordx4 v[140:143], v5, s[8:11], s85 offen offset:0
    v_mfma_f32_16x16x32_bf16 v[56:59], v[144:147], v[128:131], v[56:59]
    v_mfma_f32_16x16x32_bf16 v[60:63], v[148:151], v[128:131], v[60:63]
    v_mfma_f32_16x16x32_bf16 v[64:67], v[144:147], v[132:135], v[64:67]
    v_mfma_f32_16x16x32_bf16 v[68:71], v[148:151], v[132:135], v[68:71]
    ds_read_b128 v[104:107], v5 offset:3072
    ds_read_b128 v[108:111], v5 offset:17408
    ds_read_b128 v[112:115], v5 offset:31744
    ds_read_b128 v[116:119], v5 offset:46080
    ds_read_b128 v[120:123], v6 offset:3072
    ds_read_b128 v[124:127], v6 offset:17408
    ds_read_b128 v[128:131], v6 offset:31744
    ds_read_b128 v[132:135], v6 offset:46080
    s_waitcnt vmcnt(26) lgkmcnt(8)
    v_mfma_f32_16x16x32_bf16 v[8:11], v[152:155], v[72:75], v[8:11]
    v_mfma_f32_16x16x32_bf16 v[12:15], v[156:159], v[72:75], v[12:15]
    v_mfma_f32_16x16x32_bf16 v[16:19], v[152:155], v[76:79], v[16:19]
    v_mfma_f32_16x16x32_bf16 v[20:23], v[156:159], v[76:79], v[20:23]
    buffer_load_dwordx4 v[176:179], v5, s[8:11], s44 offen offset:2048
    buffer_load_dwordx4 v[180:183], v5, s[8:11], s44 offen offset:3072
    v_mfma_f32_16x16x32_bf16 v[24:27], v[152:155], v[80:83], v[24:27]
    v_mfma_f32_16x16x32_bf16 v[28:31], v[156:159], v[80:83], v[28:31]
    v_mfma_f32_16x16x32_bf16 v[32:35], v[152:155], v[84:87], v[32:35]
    v_mfma_f32_16x16x32_bf16 v[36:39], v[156:159], v[84:87], v[36:39]
    buffer_load_dwordx4 v[144:147], v5, s[8:11], s86 offen offset:0
    v_mfma_f32_16x16x32_bf16 v[40:43], v[152:155], v[88:91], v[40:43]
    v_mfma_f32_16x16x32_bf16 v[44:47], v[156:159], v[88:91], v[44:47]
    v_mfma_f32_16x16x32_bf16 v[48:51], v[152:155], v[92:95], v[48:51]
    v_mfma_f32_16x16x32_bf16 v[52:55], v[156:159], v[92:95], v[52:55]
    buffer_load_dwordx4 v[148:151], v5, s[8:11], s87 offen offset:0
    v_mfma_f32_16x16x32_bf16 v[56:59], v[152:155], v[96:99], v[56:59]
    v_mfma_f32_16x16x32_bf16 v[60:63], v[156:159], v[96:99], v[60:63]
    v_mfma_f32_16x16x32_bf16 v[64:67], v[152:155], v[100:103], v[64:67]
    v_mfma_f32_16x16x32_bf16 v[68:71], v[156:159], v[100:103], v[68:71]
    ds_read_b128 v[72:75], v5 offset:4096
    ds_read_b128 v[76:79], v5 offset:18432
    ds_read_b128 v[80:83], v5 offset:32768
    ds_read_b128 v[84:87], v5 offset:47104
    ds_read_b128 v[88:91], v6 offset:4096
    ds_read_b128 v[92:95], v6 offset:18432
    ds_read_b128 v[96:99], v6 offset:32768
    ds_read_b128 v[100:103], v6 offset:47104
    s_waitcnt vmcnt(8) lgkmcnt(8)
    v_mfma_f32_16x16x32_bf16 v[8:11], v[160:163], v[104:107], v[8:11]
    v_mfma_f32_16x16x32_bf16 v[12:15], v[164:167], v[104:107], v[12:15]
    v_mfma_f32_16x16x32_bf16 v[16:19], v[160:163], v[108:111], v[16:19]
    v_mfma_f32_16x16x32_bf16 v[20:23], v[164:167], v[108:111], v[20:23]
    buffer_load_dwordx4 v[184:187], v5, s[8:11], s45 offen offset:0
    buffer_load_dwordx4 v[188:191], v5, s[8:11], s45 offen offset:1024
    v_mfma_f32_16x16x32_bf16 v[24:27], v[160:163], v[112:115], v[24:27]
    v_mfma_f32_16x16x32_bf16 v[28:31], v[164:167], v[112:115], v[28:31]
    v_mfma_f32_16x16x32_bf16 v[32:35], v[160:163], v[116:119], v[32:35]
    v_mfma_f32_16x16x32_bf16 v[36:39], v[164:167], v[116:119], v[36:39]
    buffer_load_dwordx4 v[152:155], v5, s[8:11], s84 offen offset:1024
    v_mfma_f32_16x16x32_bf16 v[40:43], v[160:163], v[120:123], v[40:43]
    v_mfma_f32_16x16x32_bf16 v[44:47], v[164:167], v[120:123], v[44:47]
    v_mfma_f32_16x16x32_bf16 v[48:51], v[160:163], v[124:127], v[48:51]
    v_mfma_f32_16x16x32_bf16 v[52:55], v[164:167], v[124:127], v[52:55]
    buffer_load_dwordx4 v[156:159], v5, s[8:11], s85 offen offset:1024
    v_mfma_f32_16x16x32_bf16 v[56:59], v[160:163], v[128:131], v[56:59]
    v_mfma_f32_16x16x32_bf16 v[60:63], v[164:167], v[128:131], v[60:63]
    v_mfma_f32_16x16x32_bf16 v[64:67], v[160:163], v[132:135], v[64:67]
    v_mfma_f32_16x16x32_bf16 v[68:71], v[164:167], v[132:135], v[68:71]
    ds_read_b128 v[104:107], v5 offset:5120
    ds_read_b128 v[108:111], v5 offset:19456
    ds_read_b128 v[112:115], v5 offset:33792
    ds_read_b128 v[116:119], v5 offset:48128
    ds_read_b128 v[120:123], v6 offset:5120
    ds_read_b128 v[124:127], v6 offset:19456
    ds_read_b128 v[128:131], v6 offset:33792
    ds_read_b128 v[132:135], v6 offset:48128
    s_waitcnt vmcnt(10) lgkmcnt(8)
    v_mfma_f32_16x16x32_bf16 v[8:11], v[168:171], v[72:75], v[8:11]
    v_mfma_f32_16x16x32_bf16 v[12:15], v[172:175], v[72:75], v[12:15]
    v_mfma_f32_16x16x32_bf16 v[16:19], v[168:171], v[76:79], v[16:19]
    v_mfma_f32_16x16x32_bf16 v[20:23], v[172:175], v[76:79], v[20:23]
    buffer_load_dwordx4 v[192:195], v5, s[8:11], s45 offen offset:2048
    buffer_load_dwordx4 v[196:199], v5, s[8:11], s45 offen offset:3072
    v_mfma_f32_16x16x32_bf16 v[24:27], v[168:171], v[80:83], v[24:27]
    v_mfma_f32_16x16x32_bf16 v[28:31], v[172:175], v[80:83], v[28:31]
    v_mfma_f32_16x16x32_bf16 v[32:35], v[168:171], v[84:87], v[32:35]
    v_mfma_f32_16x16x32_bf16 v[36:39], v[172:175], v[84:87], v[36:39]
    buffer_load_dwordx4 v[160:163], v5, s[8:11], s86 offen offset:1024
    v_mfma_f32_16x16x32_bf16 v[40:43], v[168:171], v[88:91], v[40:43]
    v_mfma_f32_16x16x32_bf16 v[44:47], v[172:175], v[88:91], v[44:47]
    v_mfma_f32_16x16x32_bf16 v[48:51], v[168:171], v[92:95], v[48:51]
    v_mfma_f32_16x16x32_bf16 v[52:55], v[172:175], v[92:95], v[52:55]
    buffer_load_dwordx4 v[164:167], v5, s[8:11], s87 offen offset:1024
    v_mfma_f32_16x16x32_bf16 v[56:59], v[168:171], v[96:99], v[56:59]
    v_mfma_f32_16x16x32_bf16 v[60:63], v[172:175], v[96:99], v[60:63]
    v_mfma_f32_16x16x32_bf16 v[64:67], v[168:171], v[100:103], v[64:67]
    v_mfma_f32_16x16x32_bf16 v[68:71], v[172:175], v[100:103], v[68:71]
    ds_read_b128 v[72:75], v5 offset:6144
    ds_read_b128 v[76:79], v5 offset:20480
    ds_read_b128 v[80:83], v5 offset:34816
    ds_read_b128 v[84:87], v5 offset:49152
    ds_read_b128 v[88:91], v6 offset:6144
    ds_read_b128 v[92:95], v6 offset:20480
    ds_read_b128 v[96:99], v6 offset:34816
    ds_read_b128 v[100:103], v6 offset:49152
    s_waitcnt vmcnt(10) lgkmcnt(8)
    v_mfma_f32_16x16x32_bf16 v[8:11], v[176:179], v[104:107], v[8:11]
    v_mfma_f32_16x16x32_bf16 v[12:15], v[180:183], v[104:107], v[12:15]
    v_mfma_f32_16x16x32_bf16 v[16:19], v[176:179], v[108:111], v[16:19]
    v_mfma_f32_16x16x32_bf16 v[20:23], v[180:183], v[108:111], v[20:23]
    buffer_load_dwordx4 v[200:203], v5, s[8:11], s46 offen offset:0
    buffer_load_dwordx4 v[204:207], v5, s[8:11], s46 offen offset:1024
    v_mfma_f32_16x16x32_bf16 v[24:27], v[176:179], v[112:115], v[24:27]
    v_mfma_f32_16x16x32_bf16 v[28:31], v[180:183], v[112:115], v[28:31]
    v_mfma_f32_16x16x32_bf16 v[32:35], v[176:179], v[116:119], v[32:35]
    v_mfma_f32_16x16x32_bf16 v[36:39], v[180:183], v[116:119], v[36:39]
    buffer_load_dwordx4 v[168:171], v5, s[8:11], s84 offen offset:2048
    v_mfma_f32_16x16x32_bf16 v[40:43], v[176:179], v[120:123], v[40:43]
    v_mfma_f32_16x16x32_bf16 v[44:47], v[180:183], v[120:123], v[44:47]
    v_mfma_f32_16x16x32_bf16 v[48:51], v[176:179], v[124:127], v[48:51]
    v_mfma_f32_16x16x32_bf16 v[52:55], v[180:183], v[124:127], v[52:55]
    buffer_load_dwordx4 v[172:175], v5, s[8:11], s85 offen offset:2048
    v_mfma_f32_16x16x32_bf16 v[56:59], v[176:179], v[128:131], v[56:59]
    v_mfma_f32_16x16x32_bf16 v[60:63], v[180:183], v[128:131], v[60:63]
    v_mfma_f32_16x16x32_bf16 v[64:67], v[176:179], v[132:135], v[64:67]
    v_mfma_f32_16x16x32_bf16 v[68:71], v[180:183], v[132:135], v[68:71]
    s_waitcnt vmcnt(10) lgkmcnt(0)
    v_mfma_f32_16x16x32_bf16 v[8:11], v[184:187], v[72:75], v[8:11]
    v_mfma_f32_16x16x32_bf16 v[12:15], v[188:191], v[72:75], v[12:15]
    v_mfma_f32_16x16x32_bf16 v[16:19], v[184:187], v[76:79], v[16:19]
    v_mfma_f32_16x16x32_bf16 v[20:23], v[188:191], v[76:79], v[20:23]
    buffer_load_dwordx4 v[208:211], v5, s[8:11], s46 offen offset:2048
    buffer_load_dwordx4 v[212:215], v5, s[8:11], s46 offen offset:3072
    v_mfma_f32_16x16x32_bf16 v[24:27], v[184:187], v[80:83], v[24:27]
    v_mfma_f32_16x16x32_bf16 v[28:31], v[188:191], v[80:83], v[28:31]
    v_mfma_f32_16x16x32_bf16 v[32:35], v[184:187], v[84:87], v[32:35]
    v_mfma_f32_16x16x32_bf16 v[36:39], v[188:191], v[84:87], v[36:39]
    buffer_load_dwordx4 v[176:179], v5, s[8:11], s86 offen offset:2048
    v_mfma_f32_16x16x32_bf16 v[40:43], v[184:187], v[88:91], v[40:43]
    v_mfma_f32_16x16x32_bf16 v[44:47], v[188:191], v[88:91], v[44:47]
    v_mfma_f32_16x16x32_bf16 v[48:51], v[184:187], v[92:95], v[48:51]
    v_mfma_f32_16x16x32_bf16 v[52:55], v[188:191], v[92:95], v[52:55]
    buffer_load_dwordx4 v[180:183], v5, s[8:11], s87 offen offset:2048
    v_mfma_f32_16x16x32_bf16 v[56:59], v[184:187], v[96:99], v[56:59]
    v_mfma_f32_16x16x32_bf16 v[60:63], v[188:191], v[96:99], v[60:63]
    v_mfma_f32_16x16x32_bf16 v[64:67], v[184:187], v[100:103], v[64:67]
    v_mfma_f32_16x16x32_bf16 v[68:71], v[188:191], v[100:103], v[68:71]
    s_waitcnt vmcnt(26)
    s_barrier
    ds_read_b128 v[104:107], v5 offset:7168
    ds_read_b128 v[108:111], v5 offset:21504
    ds_read_b128 v[112:115], v5 offset:35840
    ds_read_b128 v[116:119], v5 offset:50176
    ds_read_b128 v[120:123], v6 offset:7168
    ds_read_b128 v[124:127], v6 offset:21504
    ds_read_b128 v[128:131], v6 offset:35840
    ds_read_b128 v[132:135], v6 offset:50176
    ds_read_b128 v[72:75], v5 offset:8192
    ds_read_b128 v[76:79], v5 offset:22528
    ds_read_b128 v[80:83], v5 offset:36864
    ds_read_b128 v[84:87], v5 offset:51200
    ds_read_b128 v[88:91], v6 offset:8192
    ds_read_b128 v[92:95], v6 offset:22528
    ds_read_b128 v[96:99], v6 offset:36864
    ds_read_b128 v[100:103], v6 offset:51200
    s_waitcnt vmcnt(10) lgkmcnt(8)
    v_mfma_f32_16x16x32_bf16 v[8:11], v[192:195], v[104:107], v[8:11]
    v_mfma_f32_16x16x32_bf16 v[12:15], v[196:199], v[104:107], v[12:15]
    v_mfma_f32_16x16x32_bf16 v[16:19], v[192:195], v[108:111], v[16:19]
    v_mfma_f32_16x16x32_bf16 v[20:23], v[196:199], v[108:111], v[20:23]
    buffer_load_dwordx4 v[216:219], v5, s[8:11], s47 offen offset:0
    buffer_load_dwordx4 v[220:223], v5, s[8:11], s47 offen offset:1024
    v_mfma_f32_16x16x32_bf16 v[24:27], v[192:195], v[112:115], v[24:27]
    v_mfma_f32_16x16x32_bf16 v[28:31], v[196:199], v[112:115], v[28:31]
    v_mfma_f32_16x16x32_bf16 v[32:35], v[192:195], v[116:119], v[32:35]
    v_mfma_f32_16x16x32_bf16 v[36:39], v[196:199], v[116:119], v[36:39]
    buffer_load_dwordx4 v[184:187], v5, s[8:11], s84 offen offset:3072
    v_mfma_f32_16x16x32_bf16 v[40:43], v[192:195], v[120:123], v[40:43]
    v_mfma_f32_16x16x32_bf16 v[44:47], v[196:199], v[120:123], v[44:47]
    v_mfma_f32_16x16x32_bf16 v[48:51], v[192:195], v[124:127], v[48:51]
    v_mfma_f32_16x16x32_bf16 v[52:55], v[196:199], v[124:127], v[52:55]
    buffer_load_dwordx4 v[188:191], v5, s[8:11], s85 offen offset:3072
    v_mfma_f32_16x16x32_bf16 v[56:59], v[192:195], v[128:131], v[56:59]
    v_mfma_f32_16x16x32_bf16 v[60:63], v[196:199], v[128:131], v[60:63]
    v_mfma_f32_16x16x32_bf16 v[64:67], v[192:195], v[132:135], v[64:67]
    v_mfma_f32_16x16x32_bf16 v[68:71], v[196:199], v[132:135], v[68:71]
    ds_read_b128 v[104:107], v5 offset:9216
    ds_read_b128 v[108:111], v5 offset:23552
    ds_read_b128 v[112:115], v5 offset:37888
    ds_read_b128 v[116:119], v5 offset:52224
    ds_read_b128 v[120:123], v6 offset:9216
    ds_read_b128 v[124:127], v6 offset:23552
    ds_read_b128 v[128:131], v6 offset:37888
    ds_read_b128 v[132:135], v6 offset:52224
    s_waitcnt vmcnt(10) lgkmcnt(8)
    v_mfma_f32_16x16x32_bf16 v[8:11], v[200:203], v[72:75], v[8:11]
    v_mfma_f32_16x16x32_bf16 v[12:15], v[204:207], v[72:75], v[12:15]
    v_mfma_f32_16x16x32_bf16 v[16:19], v[200:203], v[76:79], v[16:19]
    v_mfma_f32_16x16x32_bf16 v[20:23], v[204:207], v[76:79], v[20:23]
    buffer_load_dwordx4 v[224:227], v5, s[8:11], s47 offen offset:2048
    buffer_load_dwordx4 v[228:231], v5, s[8:11], s47 offen offset:3072
    v_mfma_f32_16x16x32_bf16 v[24:27], v[200:203], v[80:83], v[24:27]
    v_mfma_f32_16x16x32_bf16 v[28:31], v[204:207], v[80:83], v[28:31]
    v_mfma_f32_16x16x32_bf16 v[32:35], v[200:203], v[84:87], v[32:35]
    v_mfma_f32_16x16x32_bf16 v[36:39], v[204:207], v[84:87], v[36:39]
    buffer_load_dwordx4 v[192:195], v5, s[8:11], s86 offen offset:3072
    v_mfma_f32_16x16x32_bf16 v[40:43], v[200:203], v[88:91], v[40:43]
    v_mfma_f32_16x16x32_bf16 v[44:47], v[204:207], v[88:91], v[44:47]
    v_mfma_f32_16x16x32_bf16 v[48:51], v[200:203], v[92:95], v[48:51]
    v_mfma_f32_16x16x32_bf16 v[52:55], v[204:207], v[92:95], v[52:55]
    buffer_load_dwordx4 v[196:199], v5, s[8:11], s87 offen offset:3072
    v_mfma_f32_16x16x32_bf16 v[56:59], v[200:203], v[96:99], v[56:59]
    v_mfma_f32_16x16x32_bf16 v[60:63], v[204:207], v[96:99], v[60:63]
    v_mfma_f32_16x16x32_bf16 v[64:67], v[200:203], v[100:103], v[64:67]
    v_mfma_f32_16x16x32_bf16 v[68:71], v[204:207], v[100:103], v[68:71]
    ds_read_b128 v[72:75], v5 offset:10240
    ds_read_b128 v[76:79], v5 offset:24576
    ds_read_b128 v[80:83], v5 offset:38912
    ds_read_b128 v[84:87], v5 offset:53248
    ds_read_b128 v[88:91], v6 offset:10240
    ds_read_b128 v[92:95], v6 offset:24576
    ds_read_b128 v[96:99], v6 offset:38912
    ds_read_b128 v[100:103], v6 offset:53248
    s_waitcnt vmcnt(10) lgkmcnt(8)
    v_mfma_f32_16x16x32_bf16 v[8:11], v[208:211], v[104:107], v[8:11]
    v_mfma_f32_16x16x32_bf16 v[12:15], v[212:215], v[104:107], v[12:15]
    v_mfma_f32_16x16x32_bf16 v[16:19], v[208:211], v[108:111], v[16:19]
    v_mfma_f32_16x16x32_bf16 v[20:23], v[212:215], v[108:111], v[20:23]
    buffer_load_dwordx4 v[232:235], v5, s[8:11], s48 offen offset:0
    buffer_load_dwordx4 v[236:239], v5, s[8:11], s48 offen offset:1024
    v_mfma_f32_16x16x32_bf16 v[24:27], v[208:211], v[112:115], v[24:27]
    v_mfma_f32_16x16x32_bf16 v[28:31], v[212:215], v[112:115], v[28:31]
    v_mfma_f32_16x16x32_bf16 v[32:35], v[208:211], v[116:119], v[32:35]
    v_mfma_f32_16x16x32_bf16 v[36:39], v[212:215], v[116:119], v[36:39]
    buffer_load_dwordx4 v[200:203], v5, s[8:11], s88 offen offset:0
    v_mfma_f32_16x16x32_bf16 v[40:43], v[208:211], v[120:123], v[40:43]
    v_mfma_f32_16x16x32_bf16 v[44:47], v[212:215], v[120:123], v[44:47]
    v_mfma_f32_16x16x32_bf16 v[48:51], v[208:211], v[124:127], v[48:51]
    v_mfma_f32_16x16x32_bf16 v[52:55], v[212:215], v[124:127], v[52:55]
    buffer_load_dwordx4 v[204:207], v5, s[8:11], s89 offen offset:0
    v_mfma_f32_16x16x32_bf16 v[56:59], v[208:211], v[128:131], v[56:59]
    v_mfma_f32_16x16x32_bf16 v[60:63], v[212:215], v[128:131], v[60:63]
    v_mfma_f32_16x16x32_bf16 v[64:67], v[208:211], v[132:135], v[64:67]
    v_mfma_f32_16x16x32_bf16 v[68:71], v[212:215], v[132:135], v[68:71]
    ds_read_b128 v[104:107], v5 offset:11264
    ds_read_b128 v[108:111], v5 offset:25600
    ds_read_b128 v[112:115], v5 offset:39936
    ds_read_b128 v[116:119], v5 offset:54272
    ds_read_b128 v[120:123], v6 offset:11264
    ds_read_b128 v[124:127], v6 offset:25600
    ds_read_b128 v[128:131], v6 offset:39936
    ds_read_b128 v[132:135], v6 offset:54272
    s_waitcnt vmcnt(10) lgkmcnt(8)
    v_mfma_f32_16x16x32_bf16 v[8:11], v[216:219], v[72:75], v[8:11]
    v_mfma_f32_16x16x32_bf16 v[12:15], v[220:223], v[72:75], v[12:15]
    v_mfma_f32_16x16x32_bf16 v[16:19], v[216:219], v[76:79], v[16:19]
    v_mfma_f32_16x16x32_bf16 v[20:23], v[220:223], v[76:79], v[20:23]
    buffer_load_dwordx4 v[240:243], v5, s[8:11], s48 offen offset:2048
    buffer_load_dwordx4 v[244:247], v5, s[8:11], s48 offen offset:3072
    v_mfma_f32_16x16x32_bf16 v[24:27], v[216:219], v[80:83], v[24:27]
    v_mfma_f32_16x16x32_bf16 v[28:31], v[220:223], v[80:83], v[28:31]
    v_mfma_f32_16x16x32_bf16 v[32:35], v[216:219], v[84:87], v[32:35]
    v_mfma_f32_16x16x32_bf16 v[36:39], v[220:223], v[84:87], v[36:39]
    buffer_load_dwordx4 v[208:211], v5, s[8:11], s90 offen offset:0
    v_mfma_f32_16x16x32_bf16 v[40:43], v[216:219], v[88:91], v[40:43]
    v_mfma_f32_16x16x32_bf16 v[44:47], v[220:223], v[88:91], v[44:47]
    v_mfma_f32_16x16x32_bf16 v[48:51], v[216:219], v[92:95], v[48:51]
    v_mfma_f32_16x16x32_bf16 v[52:55], v[220:223], v[92:95], v[52:55]
    buffer_load_dwordx4 v[212:215], v5, s[8:11], s91 offen offset:0
    v_mfma_f32_16x16x32_bf16 v[56:59], v[216:219], v[96:99], v[56:59]
    v_mfma_f32_16x16x32_bf16 v[60:63], v[220:223], v[96:99], v[60:63]
    v_mfma_f32_16x16x32_bf16 v[64:67], v[216:219], v[100:103], v[64:67]
    v_mfma_f32_16x16x32_bf16 v[68:71], v[220:223], v[100:103], v[68:71]
    ds_read_b128 v[72:75], v5 offset:12288
    ds_read_b128 v[76:79], v5 offset:26624
    ds_read_b128 v[80:83], v5 offset:40960
    ds_read_b128 v[84:87], v5 offset:55296
    ds_read_b128 v[88:91], v6 offset:12288
    ds_read_b128 v[92:95], v6 offset:26624
    ds_read_b128 v[96:99], v6 offset:40960
    ds_read_b128 v[100:103], v6 offset:55296
    s_waitcnt vmcnt(10) lgkmcnt(8)
    v_mfma_f32_16x16x32_bf16 v[8:11], v[224:227], v[104:107], v[8:11]
    v_mfma_f32_16x16x32_bf16 v[12:15], v[228:231], v[104:107], v[12:15]
    v_mfma_f32_16x16x32_bf16 v[16:19], v[224:227], v[108:111], v[16:19]
    v_mfma_f32_16x16x32_bf16 v[20:23], v[228:231], v[108:111], v[20:23]
    buffer_load_dwordx4 v[216:219], v5, s[8:11], s88 offen offset:1024
    v_mfma_f32_16x16x32_bf16 v[24:27], v[224:227], v[112:115], v[24:27]
    v_mfma_f32_16x16x32_bf16 v[28:31], v[228:231], v[112:115], v[28:31]
    v_mfma_f32_16x16x32_bf16 v[32:35], v[224:227], v[116:119], v[32:35]
    v_mfma_f32_16x16x32_bf16 v[36:39], v[228:231], v[116:119], v[36:39]
    buffer_load_dwordx4 v[220:223], v5, s[8:11], s89 offen offset:1024
    v_mfma_f32_16x16x32_bf16 v[40:43], v[224:227], v[120:123], v[40:43]
    v_mfma_f32_16x16x32_bf16 v[44:47], v[228:231], v[120:123], v[44:47]
    v_mfma_f32_16x16x32_bf16 v[48:51], v[224:227], v[124:127], v[48:51]
    v_mfma_f32_16x16x32_bf16 v[52:55], v[228:231], v[124:127], v[52:55]
    v_mfma_f32_16x16x32_bf16 v[56:59], v[224:227], v[128:131], v[56:59]
    v_mfma_f32_16x16x32_bf16 v[60:63], v[228:231], v[128:131], v[60:63]
    v_mfma_f32_16x16x32_bf16 v[64:67], v[224:227], v[132:135], v[64:67]
    v_mfma_f32_16x16x32_bf16 v[68:71], v[228:231], v[132:135], v[68:71]
    ds_read_b128 v[104:107], v5 offset:13312
    ds_read_b128 v[108:111], v5 offset:27648
    ds_read_b128 v[112:115], v5 offset:41984
    ds_read_b128 v[116:119], v5 offset:56320
    ds_read_b128 v[120:123], v6 offset:13312
    ds_read_b128 v[124:127], v6 offset:27648
    ds_read_b128 v[128:131], v6 offset:41984
    ds_read_b128 v[132:135], v6 offset:56320
    s_waitcnt vmcnt(8) lgkmcnt(8)
    v_mfma_f32_16x16x32_bf16 v[8:11], v[232:235], v[72:75], v[8:11]
    v_mfma_f32_16x16x32_bf16 v[12:15], v[236:239], v[72:75], v[12:15]
    v_mfma_f32_16x16x32_bf16 v[16:19], v[232:235], v[76:79], v[16:19]
    v_mfma_f32_16x16x32_bf16 v[20:23], v[236:239], v[76:79], v[20:23]
    buffer_load_dwordx4 v[224:227], v5, s[8:11], s90 offen offset:1024
    v_mfma_f32_16x16x32_bf16 v[24:27], v[232:235], v[80:83], v[24:27]
    v_mfma_f32_16x16x32_bf16 v[28:31], v[236:239], v[80:83], v[28:31]
    v_mfma_f32_16x16x32_bf16 v[32:35], v[232:235], v[84:87], v[32:35]
    v_mfma_f32_16x16x32_bf16 v[36:39], v[236:239], v[84:87], v[36:39]
    buffer_load_dwordx4 v[228:231], v5, s[8:11], s91 offen offset:1024
    v_mfma_f32_16x16x32_bf16 v[40:43], v[232:235], v[88:91], v[40:43]
    v_mfma_f32_16x16x32_bf16 v[44:47], v[236:239], v[88:91], v[44:47]
    v_mfma_f32_16x16x32_bf16 v[48:51], v[232:235], v[92:95], v[48:51]
    v_mfma_f32_16x16x32_bf16 v[52:55], v[236:239], v[92:95], v[52:55]
    v_mfma_f32_16x16x32_bf16 v[56:59], v[232:235], v[96:99], v[56:59]
    v_mfma_f32_16x16x32_bf16 v[60:63], v[236:239], v[96:99], v[60:63]
    v_mfma_f32_16x16x32_bf16 v[64:67], v[232:235], v[100:103], v[64:67]
    v_mfma_f32_16x16x32_bf16 v[68:71], v[236:239], v[100:103], v[68:71]
    s_waitcnt vmcnt(6) lgkmcnt(0)
    v_mfma_f32_16x16x32_bf16 v[8:11], v[240:243], v[104:107], v[8:11]
    v_mfma_f32_16x16x32_bf16 v[12:15], v[244:247], v[104:107], v[12:15]
    v_mfma_f32_16x16x32_bf16 v[16:19], v[240:243], v[108:111], v[16:19]
    v_mfma_f32_16x16x32_bf16 v[20:23], v[244:247], v[108:111], v[20:23]
    buffer_load_dwordx4 v[232:235], v5, s[8:11], s88 offen offset:2048
    v_mfma_f32_16x16x32_bf16 v[24:27], v[240:243], v[112:115], v[24:27]
    v_mfma_f32_16x16x32_bf16 v[28:31], v[244:247], v[112:115], v[28:31]
    v_mfma_f32_16x16x32_bf16 v[32:35], v[240:243], v[116:119], v[32:35]
    v_mfma_f32_16x16x32_bf16 v[36:39], v[244:247], v[116:119], v[36:39]
    buffer_load_dwordx4 v[236:239], v5, s[8:11], s89 offen offset:2048
    v_mfma_f32_16x16x32_bf16 v[40:43], v[240:243], v[120:123], v[40:43]
    v_mfma_f32_16x16x32_bf16 v[44:47], v[244:247], v[120:123], v[44:47]
    v_mfma_f32_16x16x32_bf16 v[48:51], v[240:243], v[124:127], v[48:51]
    v_mfma_f32_16x16x32_bf16 v[52:55], v[244:247], v[124:127], v[52:55]
    v_mfma_f32_16x16x32_bf16 v[56:59], v[240:243], v[128:131], v[56:59]
    v_mfma_f32_16x16x32_bf16 v[60:63], v[244:247], v[128:131], v[60:63]
    v_mfma_f32_16x16x32_bf16 v[64:67], v[240:243], v[132:135], v[64:67]
    v_mfma_f32_16x16x32_bf16 v[68:71], v[244:247], v[132:135], v[68:71]
    v_lshlrev_b32 v2, 3, v3
    v_add_u32 v2, 114688, v2
    ds_read_b64 v[72:73], v2 offset:0
    ds_read_b64 v[74:75], v2 offset:128
    ds_read_b64 v[76:77], v2 offset:256
    ds_read_b64 v[78:79], v2 offset:384
    ds_read_b64 v[80:81], v2 offset:512
    ds_read_b64 v[82:83], v2 offset:640
    ds_read_b64 v[84:85], v2 offset:768
    ds_read_b64 v[86:87], v2 offset:896
    s_lshl_b32 s33, s22, 1
    s_and_b32 s34, s3, 1
    s_add_u32 s33, s33, s34
    s_mul_i32 s33, s33, 224
    s_lshr_b32 s34, s23, 1
    s_add_u32 s33, s33, s34
    s_lshl_b32 s33, s33, 10
    s_add_u32 s33, s33, s82
    s_lshr_b32 s34, s3, 1
    s_lshl_b32 s34, s34, 13
    s_add_u32 s34, s34, 118784
    s_and_b32 s35, s3, 1
    s_lshl_b32 s38, s35, 3
    s_add_u32 s38, s38, s34
    v_add_u32 v2, s38, v5
    s_lshl_b32 s38, s35, 12
    s_add_u32 s38, s38, s34
    v_add_u32 v6, s38, v5
    v_mov_b32 v7, 0xbfb8aa3b
    buffer_load_dwordx4 v[240:243], v5, s[8:11], s90 offen offset:2048
    buffer_load_dwordx4 v[244:247], v5, s[8:11], s91 offen offset:2048
    s_waitcnt lgkmcnt(0)
    v_mul_f32 v88, v73, v7
    v_fma_f32 v8, -v72, v248, v8
    v_fma_f32 v9, -v72, v249, v9
    v_fma_f32 v10, -v72, v250, v10
    v_fma_f32 v11, -v72, v251, v11
    v_fma_f32 v12, -v72, v252, v12
    v_fma_f32 v13, -v72, v253, v13
    v_fma_f32 v14, -v72, v254, v14
    v_fma_f32 v15, -v72, v255, v15
    v_mul_f32 v8, v8, v88
    v_mul_f32 v9, v9, v88
    v_mul_f32 v10, v10, v88
    v_mul_f32 v11, v11, v88
    v_exp_f32 v8, v8
    v_exp_f32 v9, v9
    v_exp_f32 v10, v10
    v_exp_f32 v11, v11
    v_mul_f32 v12, v12, v73
    v_mul_f32 v13, v13, v73
    v_mul_f32 v14, v14, v73
    v_mul_f32 v15, v15, v73
    v_add_f32 v8, 1.0, v8
    v_add_f32 v9, 1.0, v9
    v_add_f32 v10, 1.0, v10
    v_add_f32 v11, 1.0, v11
    v_rcp_f32 v8, v8
    v_rcp_f32 v9, v9
    v_rcp_f32 v10, v10
    v_rcp_f32 v11, v11
    v_mul_f32 v8, v8, v12
    v_mul_f32 v9, v9, v13
    v_mul_f32 v10, v10, v14
    v_mul_f32 v11, v11, v15
    v_cvt_pk_bf16_f32 v92, v8, v9
    v_cvt_pk_bf16_f32 v93, v10, v11
    ds_write_b64 v2, v[92:93] offset:0
    v_mul_f32 v96, v75, v7
    v_fma_f32 v16, -v74, v248, v16
    v_fma_f32 v17, -v74, v249, v17
    v_fma_f32 v18, -v74, v250, v18
    v_fma_f32 v19, -v74, v251, v19
    v_fma_f32 v20, -v74, v252, v20
    v_fma_f32 v21, -v74, v253, v21
    v_fma_f32 v22, -v74, v254, v22
    v_fma_f32 v23, -v74, v255, v23
    v_mul_f32 v16, v16, v96
    v_mul_f32 v17, v17, v96
    v_mul_f32 v18, v18, v96
    v_mul_f32 v19, v19, v96
    v_exp_f32 v16, v16
    v_exp_f32 v17, v17
    v_exp_f32 v18, v18
    v_exp_f32 v19, v19
    v_mul_f32 v20, v20, v75
    v_mul_f32 v21, v21, v75
    v_mul_f32 v22, v22, v75
    v_mul_f32 v23, v23, v75
    v_add_f32 v16, 1.0, v16
    v_add_f32 v17, 1.0, v17
    v_add_f32 v18, 1.0, v18
    v_add_f32 v19, 1.0, v19
    v_rcp_f32 v16, v16
    v_rcp_f32 v17, v17
    v_rcp_f32 v18, v18
    v_rcp_f32 v19, v19
    v_mul_f32 v16, v16, v20
    v_mul_f32 v17, v17, v21
    v_mul_f32 v18, v18, v22
    v_mul_f32 v19, v19, v23
    v_cvt_pk_bf16_f32 v100, v16, v17
    v_cvt_pk_bf16_f32 v101, v18, v19
    ds_write_b64 v2, v[100:101] offset:1024
    v_mul_f32 v88, v77, v7
    v_fma_f32 v24, -v76, v248, v24
    v_fma_f32 v25, -v76, v249, v25
    v_fma_f32 v26, -v76, v250, v26
    v_fma_f32 v27, -v76, v251, v27
    v_fma_f32 v28, -v76, v252, v28
    v_fma_f32 v29, -v76, v253, v29
    v_fma_f32 v30, -v76, v254, v30
    v_fma_f32 v31, -v76, v255, v31
    v_mul_f32 v24, v24, v88
    v_mul_f32 v25, v25, v88
    v_mul_f32 v26, v26, v88
    v_mul_f32 v27, v27, v88
    v_exp_f32 v24, v24
    v_exp_f32 v25, v25
    v_exp_f32 v26, v26
    v_exp_f32 v27, v27
    v_mul_f32 v28, v28, v77
    v_mul_f32 v29, v29, v77
    v_mul_f32 v30, v30, v77
    v_mul_f32 v31, v31, v77
    v_add_f32 v24, 1.0, v24
    v_add_f32 v25, 1.0, v25
    v_add_f32 v26, 1.0, v26
    v_add_f32 v27, 1.0, v27
    v_rcp_f32 v24, v24
    v_rcp_f32 v25, v25
    v_rcp_f32 v26, v26
    v_rcp_f32 v27, v27
    v_mul_f32 v24, v24, v28
    v_mul_f32 v25, v25, v29
    v_mul_f32 v26, v26, v30
    v_mul_f32 v27, v27, v31
    v_cvt_pk_bf16_f32 v92, v24, v25
    v_cvt_pk_bf16_f32 v93, v26, v27
    ds_write_b64 v2, v[92:93] offset:2048
    v_mul_f32 v96, v79, v7
    v_fma_f32 v32, -v78, v248, v32
    v_fma_f32 v33, -v78, v249, v33
    v_fma_f32 v34, -v78, v250, v34
    v_fma_f32 v35, -v78, v251, v35
    v_fma_f32 v36, -v78, v252, v36
    v_fma_f32 v37, -v78, v253, v37
    v_fma_f32 v38, -v78, v254, v38
    v_fma_f32 v39, -v78, v255, v39
    v_mul_f32 v32, v32, v96
    v_mul_f32 v33, v33, v96
    v_mul_f32 v34, v34, v96
    v_mul_f32 v35, v35, v96
    v_exp_f32 v32, v32
    v_exp_f32 v33, v33
    v_exp_f32 v34, v34
    v_exp_f32 v35, v35
    v_mul_f32 v36, v36, v79
    v_mul_f32 v37, v37, v79
    v_mul_f32 v38, v38, v79
    v_mul_f32 v39, v39, v79
    v_add_f32 v32, 1.0, v32
    v_add_f32 v33, 1.0, v33
    v_add_f32 v34, 1.0, v34
    v_add_f32 v35, 1.0, v35
    v_rcp_f32 v32, v32
    v_rcp_f32 v33, v33
    v_rcp_f32 v34, v34
    v_rcp_f32 v35, v35
    v_mul_f32 v32, v32, v36
    v_mul_f32 v33, v33, v37
    v_mul_f32 v34, v34, v38
    v_mul_f32 v35, v35, v39
    v_cvt_pk_bf16_f32 v100, v32, v33
    v_cvt_pk_bf16_f32 v101, v34, v35
    ds_write_b64 v2, v[100:101] offset:3072
    v_mul_f32 v88, v81, v7
    v_fma_f32 v40, -v80, v248, v40
    v_fma_f32 v41, -v80, v249, v41
    v_fma_f32 v42, -v80, v250, v42
    v_fma_f32 v43, -v80, v251, v43
    v_fma_f32 v44, -v80, v252, v44
    v_fma_f32 v45, -v80, v253, v45
    v_fma_f32 v46, -v80, v254, v46
    v_fma_f32 v47, -v80, v255, v47
    v_mul_f32 v40, v40, v88
    v_mul_f32 v41, v41, v88
    v_mul_f32 v42, v42, v88
    v_mul_f32 v43, v43, v88
    v_exp_f32 v40, v40
    v_exp_f32 v41, v41
    v_exp_f32 v42, v42
    v_exp_f32 v43, v43
    v_mul_f32 v44, v44, v81
    v_mul_f32 v45, v45, v81
    v_mul_f32 v46, v46, v81
    v_mul_f32 v47, v47, v81
    v_add_f32 v40, 1.0, v40
    v_add_f32 v41, 1.0, v41
    v_add_f32 v42, 1.0, v42
    v_add_f32 v43, 1.0, v43
    v_rcp_f32 v40, v40
    v_rcp_f32 v41, v41
    v_rcp_f32 v42, v42
    v_rcp_f32 v43, v43
    v_mul_f32 v40, v40, v44
    v_mul_f32 v41, v41, v45
    v_mul_f32 v42, v42, v46
    v_mul_f32 v43, v43, v47
    v_cvt_pk_bf16_f32 v92, v40, v41
    v_cvt_pk_bf16_f32 v93, v42, v43
    ds_write_b64 v2, v[92:93] offset:4096
    v_mul_f32 v96, v83, v7
    v_fma_f32 v48, -v82, v248, v48
    v_fma_f32 v49, -v82, v249, v49
    v_fma_f32 v50, -v82, v250, v50
    v_fma_f32 v51, -v82, v251, v51
    v_fma_f32 v52, -v82, v252, v52
    v_fma_f32 v53, -v82, v253, v53
    v_fma_f32 v54, -v82, v254, v54
    v_fma_f32 v55, -v82, v255, v55
    v_mul_f32 v48, v48, v96
    v_mul_f32 v49, v49, v96
    v_mul_f32 v50, v50, v96
    v_mul_f32 v51, v51, v96
    v_exp_f32 v48, v48
    v_exp_f32 v49, v49
    v_exp_f32 v50, v50
    v_exp_f32 v51, v51
    v_mul_f32 v52, v52, v83
    v_mul_f32 v53, v53, v83
    v_mul_f32 v54, v54, v83
    v_mul_f32 v55, v55, v83
    v_add_f32 v48, 1.0, v48
    v_add_f32 v49, 1.0, v49
    v_add_f32 v50, 1.0, v50
    v_add_f32 v51, 1.0, v51
    v_rcp_f32 v48, v48
    v_rcp_f32 v49, v49
    v_rcp_f32 v50, v50
    v_rcp_f32 v51, v51
    v_mul_f32 v48, v48, v52
    v_mul_f32 v49, v49, v53
    v_mul_f32 v50, v50, v54
    v_mul_f32 v51, v51, v55
    v_cvt_pk_bf16_f32 v100, v48, v49
    v_cvt_pk_bf16_f32 v101, v50, v51
    ds_write_b64 v2, v[100:101] offset:5120
    v_mul_f32 v88, v85, v7
    v_fma_f32 v56, -v84, v248, v56
    v_fma_f32 v57, -v84, v249, v57
    v_fma_f32 v58, -v84, v250, v58
    v_fma_f32 v59, -v84, v251, v59
    v_fma_f32 v60, -v84, v252, v60
    v_fma_f32 v61, -v84, v253, v61
    v_fma_f32 v62, -v84, v254, v62
    v_fma_f32 v63, -v84, v255, v63
    v_mul_f32 v56, v56, v88
    v_mul_f32 v57, v57, v88
    v_mul_f32 v58, v58, v88
    v_mul_f32 v59, v59, v88
    v_exp_f32 v56, v56
    v_exp_f32 v57, v57
    v_exp_f32 v58, v58
    v_exp_f32 v59, v59
    v_mul_f32 v60, v60, v85
    v_mul_f32 v61, v61, v85
    v_mul_f32 v62, v62, v85
    v_mul_f32 v63, v63, v85
    v_add_f32 v56, 1.0, v56
    v_add_f32 v57, 1.0, v57
    v_add_f32 v58, 1.0, v58
    v_add_f32 v59, 1.0, v59
    v_rcp_f32 v56, v56
    v_rcp_f32 v57, v57
    v_rcp_f32 v58, v58
    v_rcp_f32 v59, v59
    v_mul_f32 v56, v56, v60
    v_mul_f32 v57, v57, v61
    v_mul_f32 v58, v58, v62
    v_mul_f32 v59, v59, v63
    v_cvt_pk_bf16_f32 v92, v56, v57
    v_cvt_pk_bf16_f32 v93, v58, v59
    ds_write_b64 v2, v[92:93] offset:6144
    v_mul_f32 v96, v87, v7
    v_fma_f32 v64, -v86, v248, v64
    v_fma_f32 v65, -v86, v249, v65
    v_fma_f32 v66, -v86, v250, v66
    v_fma_f32 v67, -v86, v251, v67
    v_fma_f32 v68, -v86, v252, v68
    v_fma_f32 v69, -v86, v253, v69
    v_fma_f32 v70, -v86, v254, v70
    v_fma_f32 v71, -v86, v255, v71
    v_mul_f32 v64, v64, v96
    v_mul_f32 v65, v65, v96
    v_mul_f32 v66, v66, v96
    v_mul_f32 v67, v67, v96
    v_exp_f32 v64, v64
    v_exp_f32 v65, v65
    v_exp_f32 v66, v66
    v_exp_f32 v67, v67
    v_mul_f32 v68, v68, v87
    v_mul_f32 v69, v69, v87
    v_mul_f32 v70, v70, v87
    v_mul_f32 v71, v71, v87
    v_add_f32 v64, 1.0, v64
    v_add_f32 v65, 1.0, v65
    v_add_f32 v66, 1.0, v66
    v_add_f32 v67, 1.0, v67
    v_rcp_f32 v64, v64
    v_rcp_f32 v65, v65
    v_rcp_f32 v66, v66
    v_rcp_f32 v67, v67
    v_mul_f32 v64, v64, v68
    v_mul_f32 v65, v65, v69
    v_mul_f32 v66, v66, v70
    v_mul_f32 v67, v67, v71
    v_cvt_pk_bf16_f32 v100, v64, v65
    v_cvt_pk_bf16_f32 v101, v66, v67
    ds_write_b64 v2, v[100:101] offset:7168
    s_waitcnt lgkmcnt(0)
    s_barrier
    ds_read_b128 v[8:11], v6 offset:0
    ds_read_b128 v[12:15], v6 offset:1024
    ds_read_b128 v[16:19], v6 offset:2048
    ds_read_b128 v[20:23], v6 offset:3072
    s_waitcnt lgkmcnt(3)
    s_add_u32 s34, s33, 0
    buffer_store_dwordx4 v[8:11], v5, s[8:11], s34 offen sc1
    s_waitcnt lgkmcnt(2)
    s_add_u32 s34, s33, 57344
    buffer_store_dwordx4 v[12:15], v5, s[8:11], s34 offen sc1
    s_waitcnt lgkmcnt(1)
    s_add_u32 s34, s33, 114688
    buffer_store_dwordx4 v[16:19], v5, s[8:11], s34 offen sc1
    s_waitcnt lgkmcnt(0)
    s_add_u32 s34, s33, 172032
    buffer_store_dwordx4 v[20:23], v5, s[8:11], s34 offen sc1
    s_add_u32 s49, s49, 4096
    s_waitcnt vmcnt(0)
    s_barrier
    s_cmp_lg_u32 s3, 0
    s_cbranch_scc1 pub_skip_b
    v_mov_b32 v1, 0
    v_mov_b32 v2, 1
    s_mov_b64 s[58:59], exec
    s_mov_b64 exec, 1
    buffer_atomic_add v2, v1, s[8:11], s49 offen sc1
    s_mov_b64 exec, s[58:59]
    v_and_b32 v1, 63, v0
pub_skip_b:
    s_nop 4
    s_cmp_lg_u32 s3, 7
    s_cbranch_scc1 sync_skip_b
    v_mov_b32 v1, 0
    s_mov_b64 s[58:59], exec
    s_mov_b64 exec, 1
    s_mov_b32 s56, 0
sync_poll_b:
    buffer_load_dword v2, v1, s[8:11], s51 offen sc1
    s_waitcnt vmcnt(0)
    v_readfirstlane_b32 s57, v2
    s_nop 0
    s_cmp_ge_u32 s57, 14
    s_cbranch_scc1 sync_done_b
    s_sleep 1
    s_add_u32 s56, s56, 1
    s_cmp_lt_u32 s56, 0x8000
    s_cbranch_scc1 sync_poll_b
sync_done_b:
    s_mov_b64 exec, s[58:59]
    v_and_b32 v1, 63, v0
sync_skip_b:
    s_nop 4
    s_barrier
    s_and_b32 s20, s2, 7
    s_lshr_b32 s21, s2, 3
    s_lshl_b32 s22, s20, 2
    s_and_b32 s23, s21, 3
    s_add_u32 s22, s22, s23
    s_lshr_b32 s23, s21, 2
    s_lshr_b32 s24, s3, 1
    s_lshl_b32 s25, s22, 2
    s_add_u32 s24, s24, s25
    s_and_b32 s25, s3, 1
    s_lshl_b32 s26, s23, 1
    s_add_u32 s25, s25, s26
    s_mul_i32 s26, s24, 14
    s_add_u32 s26, s26, s25
    s_mul_i32 s27, s3, 7
    s_mul_i32 s29, s22, 224
    s_add_u32 s29, s29, s27
    s_lshl_b32 s29, s29, 10
    s_add_u32 s29, s29, s82
    s_add_u32 s42, s29, 0
    s_add_u32 s46, s29, 4096
    s_add_u32 s43, s29, 57344
    s_add_u32 s47, s29, 61440
    s_add_u32 s44, s29, 114688
    s_add_u32 s48, s29, 118784
    s_add_u32 s45, s29, 172032
    s_add_u32 s39, s29, 176128
    buffer_load_dwordx4 v[80:83], v5, s[8:11], s42 offen offset:0 sc1
    buffer_load_dwordx4 v[84:87], v5, s[8:11], s43 offen offset:0 sc1
    buffer_load_dwordx4 v[88:91], v5, s[8:11], s44 offen offset:0 sc1
    buffer_load_dwordx4 v[92:95], v5, s[8:11], s45 offen offset:0 sc1
    buffer_load_dwordx4 v[96:99], v5, s[8:11], s42 offen offset:1024 sc1
    buffer_load_dwordx4 v[100:103], v5, s[8:11], s43 offen offset:1024 sc1
    buffer_load_dwordx4 v[104:107], v5, s[8:11], s44 offen offset:1024 sc1
    buffer_load_dwordx4 v[108:111], v5, s[8:11], s45 offen offset:1024 sc1
    buffer_load_dwordx4 v[112:115], v5, s[8:11], s42 offen offset:2048 sc1
    buffer_load_dwordx4 v[116:119], v5, s[8:11], s43 offen offset:2048 sc1
    buffer_load_dwordx4 v[120:123], v5, s[8:11], s44 offen offset:2048 sc1
    buffer_load_dwordx4 v[124:127], v5, s[8:11], s45 offen offset:2048 sc1
    s_lshl_b32 s30, s26, 10
    s_add_u32 s30, s30, s80
    buffer_load_dwordx4 v[12:15], v5, s[8:11], s30 offen sc1
    s_waitcnt vmcnt(9)
    v_mfma_f32_16x16x32_bf16 v[16:19], v[136:139], v[80:83], 0
    v_mfma_f32_16x16x32_bf16 v[20:23], v[140:143], v[80:83], 0
    v_mfma_f32_16x16x32_bf16 v[24:27], v[144:147], v[80:83], 0
    v_mfma_f32_16x16x32_bf16 v[28:31], v[148:151], v[80:83], 0
    v_mfma_f32_16x16x32_bf16 v[32:35], v[136:139], v[84:87], 0
    v_mfma_f32_16x16x32_bf16 v[36:39], v[140:143], v[84:87], 0
    v_mfma_f32_16x16x32_bf16 v[40:43], v[144:147], v[84:87], 0
    v_mfma_f32_16x16x32_bf16 v[44:47], v[148:151], v[84:87], 0
    v_mfma_f32_16x16x32_bf16 v[48:51], v[136:139], v[88:91], 0
    v_mfma_f32_16x16x32_bf16 v[52:55], v[140:143], v[88:91], 0
    v_mfma_f32_16x16x32_bf16 v[56:59], v[144:147], v[88:91], 0
    v_mfma_f32_16x16x32_bf16 v[60:63], v[148:151], v[88:91], 0
    v_mfma_f32_16x16x32_bf16 v[64:67], v[136:139], v[92:95], 0
    v_mfma_f32_16x16x32_bf16 v[68:71], v[140:143], v[92:95], 0
    v_mfma_f32_16x16x32_bf16 v[72:75], v[144:147], v[92:95], 0
    v_mfma_f32_16x16x32_bf16 v[76:79], v[148:151], v[92:95], 0
    buffer_load_dwordx4 v[80:83], v5, s[8:11], s42 offen offset:3072 sc1
    buffer_load_dwordx4 v[84:87], v5, s[8:11], s43 offen offset:3072 sc1
    buffer_load_dwordx4 v[88:91], v5, s[8:11], s44 offen offset:3072 sc1
    buffer_load_dwordx4 v[92:95], v5, s[8:11], s45 offen offset:3072 sc1
    s_waitcnt vmcnt(9)
    v_mfma_f32_16x16x32_bf16 v[16:19], v[152:155], v[96:99], v[16:19]
    v_mfma_f32_16x16x32_bf16 v[20:23], v[156:159], v[96:99], v[20:23]
    v_mfma_f32_16x16x32_bf16 v[24:27], v[160:163], v[96:99], v[24:27]
    v_mfma_f32_16x16x32_bf16 v[28:31], v[164:167], v[96:99], v[28:31]
    v_mfma_f32_16x16x32_bf16 v[32:35], v[152:155], v[100:103], v[32:35]
    v_mfma_f32_16x16x32_bf16 v[36:39], v[156:159], v[100:103], v[36:39]
    v_mfma_f32_16x16x32_bf16 v[40:43], v[160:163], v[100:103], v[40:43]
    v_mfma_f32_16x16x32_bf16 v[44:47], v[164:167], v[100:103], v[44:47]
    v_mfma_f32_16x16x32_bf16 v[48:51], v[152:155], v[104:107], v[48:51]
    v_mfma_f32_16x16x32_bf16 v[52:55], v[156:159], v[104:107], v[52:55]
    v_mfma_f32_16x16x32_bf16 v[56:59], v[160:163], v[104:107], v[56:59]
    v_mfma_f32_16x16x32_bf16 v[60:63], v[164:167], v[104:107], v[60:63]
    v_mfma_f32_16x16x32_bf16 v[64:67], v[152:155], v[108:111], v[64:67]
    v_mfma_f32_16x16x32_bf16 v[68:71], v[156:159], v[108:111], v[68:71]
    v_mfma_f32_16x16x32_bf16 v[72:75], v[160:163], v[108:111], v[72:75]
    v_mfma_f32_16x16x32_bf16 v[76:79], v[164:167], v[108:111], v[76:79]
    buffer_load_dwordx4 v[96:99], v5, s[8:11], s46 offen offset:0 sc1
    buffer_load_dwordx4 v[100:103], v5, s[8:11], s47 offen offset:0 sc1
    buffer_load_dwordx4 v[104:107], v5, s[8:11], s48 offen offset:0 sc1
    buffer_load_dwordx4 v[108:111], v5, s[8:11], s39 offen offset:0 sc1
    s_waitcnt vmcnt(9)
    v_mfma_f32_16x16x32_bf16 v[16:19], v[168:171], v[112:115], v[16:19]
    v_mfma_f32_16x16x32_bf16 v[20:23], v[172:175], v[112:115], v[20:23]
    v_mfma_f32_16x16x32_bf16 v[24:27], v[176:179], v[112:115], v[24:27]
    v_mfma_f32_16x16x32_bf16 v[28:31], v[180:183], v[112:115], v[28:31]
    v_mfma_f32_16x16x32_bf16 v[32:35], v[168:171], v[116:119], v[32:35]
    v_mfma_f32_16x16x32_bf16 v[36:39], v[172:175], v[116:119], v[36:39]
    v_mfma_f32_16x16x32_bf16 v[40:43], v[176:179], v[116:119], v[40:43]
    v_mfma_f32_16x16x32_bf16 v[44:47], v[180:183], v[116:119], v[44:47]
    v_mfma_f32_16x16x32_bf16 v[48:51], v[168:171], v[120:123], v[48:51]
    v_mfma_f32_16x16x32_bf16 v[52:55], v[172:175], v[120:123], v[52:55]
    v_mfma_f32_16x16x32_bf16 v[56:59], v[176:179], v[120:123], v[56:59]
    v_mfma_f32_16x16x32_bf16 v[60:63], v[180:183], v[120:123], v[60:63]
    v_mfma_f32_16x16x32_bf16 v[64:67], v[168:171], v[124:127], v[64:67]
    v_mfma_f32_16x16x32_bf16 v[68:71], v[172:175], v[124:127], v[68:71]
    v_mfma_f32_16x16x32_bf16 v[72:75], v[176:179], v[124:127], v[72:75]
    v_mfma_f32_16x16x32_bf16 v[76:79], v[180:183], v[124:127], v[76:79]
    buffer_load_dwordx4 v[112:115], v5, s[8:11], s46 offen offset:1024 sc1
    buffer_load_dwordx4 v[116:119], v5, s[8:11], s47 offen offset:1024 sc1
    buffer_load_dwordx4 v[120:123], v5, s[8:11], s48 offen offset:1024 sc1
    buffer_load_dwordx4 v[124:127], v5, s[8:11], s39 offen offset:1024 sc1
    s_waitcnt vmcnt(8)
    v_mfma_f32_16x16x32_bf16 v[16:19], v[184:187], v[80:83], v[16:19]
    v_mfma_f32_16x16x32_bf16 v[20:23], v[188:191], v[80:83], v[20:23]
    v_mfma_f32_16x16x32_bf16 v[24:27], v[192:195], v[80:83], v[24:27]
    v_mfma_f32_16x16x32_bf16 v[28:31], v[196:199], v[80:83], v[28:31]
    v_mfma_f32_16x16x32_bf16 v[32:35], v[184:187], v[84:87], v[32:35]
    v_mfma_f32_16x16x32_bf16 v[36:39], v[188:191], v[84:87], v[36:39]
    v_mfma_f32_16x16x32_bf16 v[40:43], v[192:195], v[84:87], v[40:43]
    v_mfma_f32_16x16x32_bf16 v[44:47], v[196:199], v[84:87], v[44:47]
    v_mfma_f32_16x16x32_bf16 v[48:51], v[184:187], v[88:91], v[48:51]
    v_mfma_f32_16x16x32_bf16 v[52:55], v[188:191], v[88:91], v[52:55]
    v_mfma_f32_16x16x32_bf16 v[56:59], v[192:195], v[88:91], v[56:59]
    v_mfma_f32_16x16x32_bf16 v[60:63], v[196:199], v[88:91], v[60:63]
    v_mfma_f32_16x16x32_bf16 v[64:67], v[184:187], v[92:95], v[64:67]
    v_mfma_f32_16x16x32_bf16 v[68:71], v[188:191], v[92:95], v[68:71]
    v_mfma_f32_16x16x32_bf16 v[72:75], v[192:195], v[92:95], v[72:75]
    v_mfma_f32_16x16x32_bf16 v[76:79], v[196:199], v[92:95], v[76:79]
    buffer_load_dwordx4 v[80:83], v5, s[8:11], s46 offen offset:2048 sc1
    buffer_load_dwordx4 v[84:87], v5, s[8:11], s47 offen offset:2048 sc1
    buffer_load_dwordx4 v[88:91], v5, s[8:11], s48 offen offset:2048 sc1
    buffer_load_dwordx4 v[92:95], v5, s[8:11], s39 offen offset:2048 sc1
    s_waitcnt vmcnt(8)
    v_mfma_f32_16x16x32_bf16 v[16:19], v[200:203], v[96:99], v[16:19]
    v_mfma_f32_16x16x32_bf16 v[20:23], v[204:207], v[96:99], v[20:23]
    v_mfma_f32_16x16x32_bf16 v[24:27], v[208:211], v[96:99], v[24:27]
    v_mfma_f32_16x16x32_bf16 v[28:31], v[212:215], v[96:99], v[28:31]
    v_mfma_f32_16x16x32_bf16 v[32:35], v[200:203], v[100:103], v[32:35]
    v_mfma_f32_16x16x32_bf16 v[36:39], v[204:207], v[100:103], v[36:39]
    v_mfma_f32_16x16x32_bf16 v[40:43], v[208:211], v[100:103], v[40:43]
    v_mfma_f32_16x16x32_bf16 v[44:47], v[212:215], v[100:103], v[44:47]
    v_mfma_f32_16x16x32_bf16 v[48:51], v[200:203], v[104:107], v[48:51]
    v_mfma_f32_16x16x32_bf16 v[52:55], v[204:207], v[104:107], v[52:55]
    v_mfma_f32_16x16x32_bf16 v[56:59], v[208:211], v[104:107], v[56:59]
    v_mfma_f32_16x16x32_bf16 v[60:63], v[212:215], v[104:107], v[60:63]
    v_mfma_f32_16x16x32_bf16 v[64:67], v[200:203], v[108:111], v[64:67]
    v_mfma_f32_16x16x32_bf16 v[68:71], v[204:207], v[108:111], v[68:71]
    v_mfma_f32_16x16x32_bf16 v[72:75], v[208:211], v[108:111], v[72:75]
    v_mfma_f32_16x16x32_bf16 v[76:79], v[212:215], v[108:111], v[76:79]
    s_waitcnt vmcnt(4)
    v_mfma_f32_16x16x32_bf16 v[16:19], v[216:219], v[112:115], v[16:19]
    v_mfma_f32_16x16x32_bf16 v[20:23], v[220:223], v[112:115], v[20:23]
    v_mfma_f32_16x16x32_bf16 v[24:27], v[224:227], v[112:115], v[24:27]
    v_mfma_f32_16x16x32_bf16 v[28:31], v[228:231], v[112:115], v[28:31]
    v_mfma_f32_16x16x32_bf16 v[32:35], v[216:219], v[116:119], v[32:35]
    v_mfma_f32_16x16x32_bf16 v[36:39], v[220:223], v[116:119], v[36:39]
    v_mfma_f32_16x16x32_bf16 v[40:43], v[224:227], v[116:119], v[40:43]
    v_mfma_f32_16x16x32_bf16 v[44:47], v[228:231], v[116:119], v[44:47]
    v_mfma_f32_16x16x32_bf16 v[48:51], v[216:219], v[120:123], v[48:51]
    v_mfma_f32_16x16x32_bf16 v[52:55], v[220:223], v[120:123], v[52:55]
    v_mfma_f32_16x16x32_bf16 v[56:59], v[224:227], v[120:123], v[56:59]
    v_mfma_f32_16x16x32_bf16 v[60:63], v[228:231], v[120:123], v[60:63]
    v_mfma_f32_16x16x32_bf16 v[64:67], v[216:219], v[124:127], v[64:67]
    v_mfma_f32_16x16x32_bf16 v[68:71], v[220:223], v[124:127], v[68:71]
    v_mfma_f32_16x16x32_bf16 v[72:75], v[224:227], v[124:127], v[72:75]
    v_mfma_f32_16x16x32_bf16 v[76:79], v[228:231], v[124:127], v[76:79]
    s_waitcnt vmcnt(0)
    v_mfma_f32_16x16x32_bf16 v[16:19], v[232:235], v[80:83], v[16:19]
    v_mfma_f32_16x16x32_bf16 v[20:23], v[236:239], v[80:83], v[20:23]
    v_mfma_f32_16x16x32_bf16 v[24:27], v[240:243], v[80:83], v[24:27]
    v_mfma_f32_16x16x32_bf16 v[28:31], v[244:247], v[80:83], v[28:31]
    v_mfma_f32_16x16x32_bf16 v[32:35], v[232:235], v[84:87], v[32:35]
    v_mfma_f32_16x16x32_bf16 v[36:39], v[236:239], v[84:87], v[36:39]
    v_mfma_f32_16x16x32_bf16 v[40:43], v[240:243], v[84:87], v[40:43]
    v_mfma_f32_16x16x32_bf16 v[44:47], v[244:247], v[84:87], v[44:47]
    v_mfma_f32_16x16x32_bf16 v[48:51], v[232:235], v[88:91], v[48:51]
    v_mfma_f32_16x16x32_bf16 v[52:55], v[236:239], v[88:91], v[52:55]
    v_mfma_f32_16x16x32_bf16 v[56:59], v[240:243], v[88:91], v[56:59]
    v_mfma_f32_16x16x32_bf16 v[60:63], v[244:247], v[88:91], v[60:63]
    v_mfma_f32_16x16x32_bf16 v[64:67], v[232:235], v[92:95], v[64:67]
    v_mfma_f32_16x16x32_bf16 v[68:71], v[236:239], v[92:95], v[68:71]
    v_mfma_f32_16x16x32_bf16 v[72:75], v[240:243], v[92:95], v[72:75]
    v_mfma_f32_16x16x32_bf16 v[76:79], v[244:247], v[92:95], v[76:79]
    s_lshl_b32 s33, s3, 14
    v_add_u32 v9, s33, v5
    ds_write_b128 v9, v[16:19] offset:0
    ds_write_b128 v9, v[20:23] offset:1024
    ds_write_b128 v9, v[24:27] offset:2048
    ds_write_b128 v9, v[28:31] offset:3072
    ds_write_b128 v9, v[32:35] offset:4096
    ds_write_b128 v9, v[36:39] offset:5120
    ds_write_b128 v9, v[40:43] offset:6144
    ds_write_b128 v9, v[44:47] offset:7168
    ds_write_b128 v9, v[48:51] offset:8192
    ds_write_b128 v9, v[52:55] offset:9216
    ds_write_b128 v9, v[56:59] offset:10240
    ds_write_b128 v9, v[60:63] offset:11264
    ds_write_b128 v9, v[64:67] offset:12288
    ds_write_b128 v9, v[68:71] offset:13312
    ds_write_b128 v9, v[72:75] offset:14336
    ds_write_b128 v9, v[76:79] offset:15360
    s_lshl_b32 s33, s3, 11
    v_add_u32 v9, s33, v5
    v_add_u32 v10, 0x10000, v9
    s_lshl_b32 s34, s24, 4
    v_add_u32 v7, s34, v3
    v_mul_u32_u24 v7, 896, v7
    s_lshl_b32 s34, s25, 6
    v_lshlrev_b32 v11, 3, v4
    v_add3_u32 v7, v7, v11, s34
    s_lshl_b32 s34, s26, 10
    s_add_u32 s34, s34, 0xcb0000
    s_lshl_b32 s35, s26, 7
    s_add_u32 s35, s35, 0xea8000
    v_lshlrev_b32 v8, 3, v3
    v_mov_b32 v11, 0x3f803f80
    s_waitcnt lgkmcnt(0)
    s_barrier
    ds_read_b128 v[16:19], v9 offset:0
    ds_read_b128 v[20:23], v9 offset:1024
    ds_read_b128 v[24:27], v9 offset:16384
    ds_read_b128 v[28:31], v9 offset:17408
    ds_read_b128 v[32:35], v9 offset:32768
    ds_read_b128 v[36:39], v9 offset:33792
    ds_read_b128 v[40:43], v9 offset:49152
    ds_read_b128 v[44:47], v9 offset:50176
    ds_read_b128 v[48:51], v10 offset:0
    ds_read_b128 v[52:55], v10 offset:1024
    ds_read_b128 v[56:59], v10 offset:16384
    ds_read_b128 v[60:63], v10 offset:17408
    ds_read_b128 v[64:67], v10 offset:32768
    ds_read_b128 v[68:71], v10 offset:33792
    ds_read_b128 v[72:75], v10 offset:49152
    ds_read_b128 v[76:79], v10 offset:50176
    s_waitcnt lgkmcnt(8)
    v_add_f32 v16, v16, v32
    v_add_f32 v17, v17, v33
    v_add_f32 v18, v18, v34
    v_add_f32 v19, v19, v35
    v_add_f32 v20, v20, v36
    v_add_f32 v21, v21, v37
    v_add_f32 v22, v22, v38
    v_add_f32 v23, v23, v39
    v_add_f32 v24, v24, v40
    v_add_f32 v25, v25, v41
    v_add_f32 v26, v26, v42
    v_add_f32 v27, v27, v43
    v_add_f32 v28, v28, v44
    v_add_f32 v29, v29, v45
    v_add_f32 v30, v30, v46
    v_add_f32 v31, v31, v47
    s_waitcnt lgkmcnt(0)
    v_add_f32 v48, v48, v64
    v_add_f32 v49, v49, v65
    v_add_f32 v50, v50, v66
    v_add_f32 v51, v51, v67
    v_add_f32 v52, v52, v68
    v_add_f32 v53, v53, v69
    v_add_f32 v54, v54, v70
    v_add_f32 v55, v55, v71
    v_add_f32 v56, v56, v72
    v_add_f32 v57, v57, v73
    v_add_f32 v58, v58, v74
    v_add_f32 v59, v59, v75
    v_add_f32 v60, v60, v76
    v_add_f32 v61, v61, v77
    v_add_f32 v62, v62, v78
    v_add_f32 v63, v63, v79
    v_add_f32 v16, v16, v24
    v_add_f32 v48, v48, v56
    v_add_f32 v17, v17, v25
    v_add_f32 v49, v49, v57
    v_add_f32 v18, v18, v26
    v_add_f32 v50, v50, v58
    v_add_f32 v19, v19, v27
    v_add_f32 v51, v51, v59
    v_add_f32 v20, v20, v28
    v_add_f32 v52, v52, v60
    v_add_f32 v21, v21, v29
    v_add_f32 v53, v53, v61
    v_add_f32 v22, v22, v30
    v_add_f32 v54, v54, v62
    v_add_f32 v23, v23, v31
    v_add_f32 v55, v55, v63
    v_add_f32 v16, v16, v48
    v_add_f32 v17, v17, v49
    v_add_f32 v18, v18, v50
    v_add_f32 v19, v19, v51
    v_add_f32 v20, v20, v52
    v_add_f32 v21, v21, v53
    v_add_f32 v22, v22, v54
    v_add_f32 v23, v23, v55
    s_waitcnt vmcnt(16)
    v_cvt_pk_bf16_f32 v24, v16, v17
    v_cvt_pk_bf16_f32 v25, v18, v19
    v_cvt_pk_bf16_f32 v26, v20, v21
    v_cvt_pk_bf16_f32 v27, v22, v23
    v_lshlrev_b32 v16, 16, v24
    v_and_b32 v17, 0xffff0000, v24
    v_lshlrev_b32 v32, 16, v12
    v_and_b32 v33, 0xffff0000, v12
    v_lshlrev_b32 v18, 16, v25
    v_and_b32 v19, 0xffff0000, v25
    v_lshlrev_b32 v34, 16, v13
    v_and_b32 v35, 0xffff0000, v13
    v_lshlrev_b32 v20, 16, v26
    v_and_b32 v21, 0xffff0000, v26
    v_lshlrev_b32 v36, 16, v14
    v_and_b32 v37, 0xffff0000, v14
    v_lshlrev_b32 v22, 16, v27
    v_and_b32 v23, 0xffff0000, v27
    v_lshlrev_b32 v38, 16, v15
    v_and_b32 v39, 0xffff0000, v15
    v_add_f32 v16, v16, v32
    v_add_f32 v17, v17, v33
    v_add_f32 v18, v18, v34
    v_add_f32 v19, v19, v35
    v_add_f32 v20, v20, v36
    v_add_f32 v21, v21, v37
    v_add_f32 v22, v22, v38
    v_add_f32 v23, v23, v39
    v_cvt_pk_bf16_f32 v24, v16, v17
    v_cvt_pk_bf16_f32 v25, v18, v19
    v_cvt_pk_bf16_f32 v26, v20, v21
    v_cvt_pk_bf16_f32 v27, v22, v23
    s_cmp_eq_u32 s55, 0
    s_cbranch_scc1 kbC_notfinal
    buffer_store_dwordx2 v[24:25], v7, s[16:19], 0 offen
    buffer_store_dwordx2 v[26:27], v7, s[16:19], 0 offen offset:32
    s_branch kbC_fin
kbC_notfinal:
    s_nop 7
    s_nop 7
    buffer_store_dwordx4 v[24:27], v5, s[8:11], s34 offen sc1
    v_mov_b32 v40, 0
    v_mov_b32 v41, 0
    v_dot2c_f32_bf16 v40, v24, v11
    v_dot2c_f32_bf16 v41, v24, v24
    v_dot2c_f32_bf16 v40, v25, v11
    v_dot2c_f32_bf16 v41, v25, v25
    v_dot2c_f32_bf16 v40, v26, v11
    v_dot2c_f32_bf16 v41, v26, v26
    v_dot2c_f32_bf16 v40, v27, v11
    v_dot2c_f32_bf16 v41, v27, v27
    s_nop 1
    v_mov_b32 v42, v40
    v_mov_b32 v43, v41
    s_nop 0
    v_permlane16_swap_b32 v40, v42
    v_permlane16_swap_b32 v41, v43
    v_add_f32 v40, v40, v42
    v_add_f32 v41, v41, v43
    v_mov_b32 v42, v40
    v_mov_b32 v43, v41
    s_nop 0
    v_permlane32_swap_b32 v40, v42
    v_permlane32_swap_b32 v41, v43
    v_add_f32 v40, v40, v42
    v_add_f32 v41, v41, v43
    buffer_store_dwordx2 v[40:41], v8, s[8:11], s35 offen sc1
kbC_fin:
    s_nop 7
    s_nop 7
    s_cmp_lg_u32 s55, 0
    s_cbranch_scc1 kb_done
    s_add_u32 s50, s50, 8192
    s_waitcnt vmcnt(0)
    s_nop 0
    s_waitcnt vmcnt(0)
    s_barrier
    s_cmp_lg_u32 s3, 0
    s_cbranch_scc1 pub_skip_c
    v_mov_b32 v1, 0
    v_mov_b32 v2, 1
    s_mov_b64 s[58:59], exec
    s_mov_b64 exec, 1
    buffer_atomic_add v2, v1, s[8:11], s50 offen sc1
    s_mov_b64 exec, s[58:59]
    v_and_b32 v1, 63, v0
pub_skip_c:
    s_nop 4
kb_tail:
    s_nop 7
    s_nop 7
    s_cmp_lg_u32 s55, 0
    s_cbranch_scc1 kb_done
    s_add_u32 s97, s53, 8192
    s_mov_b32 s52, 0xcb0000
    s_mov_b32 s98, 0xea8000
    s_mov_b32 s53, 0x24d8000
    s_mov_b32 s54, 0x6d0000
    s_mov_b32 s55, 1
    s_mov_b32 s80, 0x19d8000
    s_mov_b32 s81, 0x1b98000
    s_mov_b32 s82, 0x1bd0000
    s_mov_b32 s83, 0x22d0000
    s_branch k1_body
kb_done:
    s_nop 7
    s_nop 7
    s_endpgm
code_end:

.section .rodata,"a"
.p2align 6
.amdhsa_kernel prep_kernel
  .amdhsa_next_free_vgpr 168
  .amdhsa_next_free_sgpr 64
  .amdhsa_accum_offset 168
  .amdhsa_group_segment_fixed_size 0
  .amdhsa_kernarg_size 88
  .amdhsa_user_sgpr_count 2
  .amdhsa_user_sgpr_kernarg_segment_ptr 1
  .amdhsa_system_sgpr_workgroup_id_x 1
  .amdhsa_float_denorm_mode_32 3
.end_amdhsa_kernel
.p2align 6
.amdhsa_kernel megal0_kernel
  .amdhsa_next_free_vgpr 256
  .amdhsa_next_free_sgpr 100
  .amdhsa_accum_offset 256
  .amdhsa_group_segment_fixed_size 0
  .amdhsa_kernarg_size 88
  .amdhsa_user_sgpr_count 2
  .amdhsa_user_sgpr_kernarg_segment_ptr 1
  .amdhsa_system_sgpr_workgroup_id_x 1
  .amdhsa_float_denorm_mode_32 3
.end_amdhsa_kernel
```
